```python
import torch

def _softmax(x, axis=-1):
    return torch.softmax(x, dim=axis)
def _gelu(x):
    return torch.nn.functional.gelu(x, approximate="tanh")
def _silu(x):
    return torch.nn.functional.silu(x)
def _sigmoid(x):
    return torch.sigmoid(x)
def _layernorm(x, axis=-1, eps=1e-5):
    m = x.mean(dim=axis, keepdim=True)
    v = x.var(dim=axis, keepdim=True, unbiased=False)
    return (x - m) / torch.sqrt(v + eps)
def _scatter_add(tgt, idx, src, axis=0):
    return tgt.clone().index_add_(axis, idx, src)
def _segment_sum(src, seg, n):
    out = torch.zeros((n,) + src.shape[1:], dtype=src.dtype)
    return out.index_add_(0, seg, src)
def _pad(x, pw):
    flat = tuple(v for pair in reversed(pw) for v in pair)
    return torch.nn.functional.pad(x, flat)

kernel_name = 'standalone__gqa_block_cached__near_ridge'

def setup_inputs():

    _w = (lambda a: (lambda t: t.to(torch.bfloat16) if t.is_floating_point() else t)(torch.as_tensor(a)))
    B, Sq, D = 8, 64, 576
    Hq, Hkv, Sk, Dh = 32, 16, 1024, 128
    assert Hq % Hkv == 0, (Hq, Hkv)
    return {
        "x": _w((lambda *s: torch.randn(*s, dtype=torch.bfloat16) * 0.8)(B, Sq, D)),
        "k_cache": _w((lambda *s: torch.randn(*s, dtype=torch.bfloat16) * 0.8)(B, Hkv, Sk, Dh)),
        "v_cache": _w((lambda *s: torch.randn(*s, dtype=torch.bfloat16) * 0.05)(B, Hkv, Sk, Dh)),
        "wq": _w((lambda *s: torch.randn(*s, dtype=torch.bfloat16) * 0.8)(D, Hq * Dh) * (D ** -0.5)),
        "wo": _w((lambda *s: torch.randn(*s, dtype=torch.bfloat16) * 0.05)(Hq * Dh, D) * ((Hq * Dh) ** -0.5)),
    }

def reference(x, k_cache, v_cache, wq, wo):
    B, Sq, D = x.shape
    Hq, Dh = 32, 128
    Hkv = k_cache.shape[1]
    rep = Hq // Hkv
    q = (lambda x, *d: x.permute(*d))((x @ wq).reshape(B, Sq, Hq, Dh), 0, 2, 1, 3)
    k = (lambda x, n, axis: torch.repeat_interleave(x, n, dim=axis))(k_cache, rep, axis=1)
    v = (lambda x, n, axis: torch.repeat_interleave(x, n, dim=axis))(v_cache, rep, axis=1)
    scores = torch.einsum("bhqd,bhkd->bhqk", q, k) * (Dh ** -0.5)
    p = _softmax(scores, axis=-1)
    o = torch.einsum("bhqk,bhkd->bhqd", p, v)
    return (lambda x, *d: x.permute(*d))(o, 0, 2, 1, 3).reshape(B, Sq, Hq * Dh) @ wo
```

```asm
; @launch grid=(256,1,1) block=(320,1,1) lds=163840
.amdgcn_target "amdgcn-amd-amdhsa--gfx950"
.text
.globl standalone__gqa_block_cached__near_ridge_kernel
.p2align 8
.type standalone__gqa_block_cached__near_ridge_kernel,@function
standalone__gqa_block_cached__near_ridge_kernel:
    s_cmp_ge_u32 s2, 256
    s_cbranch_scc1 L_end
    s_load_dwordx16 s[4:19], s[0:1], 0
    s_getpc_b64 s[74:75]
L_pcbase:
    v_lshrrev_b32 v19, 6, v0
    v_and_b32 v1, 63, v0
    v_readfirstlane_b32 s52, v19
    s_and_b32 s54, s2, 7
    s_lshr_b32 s71, s2, 3
    s_lshr_b32 s53, s71, 2
    s_and_b32 s55, s71, 3
    s_lshl_b32 s56, s53, 5
    s_lshl_b32 s58, s54, 2
    s_add_u32 s56, s56, s58
    s_add_u32 s56, s56, s55
    s_and_b32 s61, s55, 1
    s_lshl_b32 s61, s61, 14
    s_mul_i32 s57, s53, 73728
    s_lshl_b32 s58, s54, 2
    s_add_u32 s58, s58, s55
    s_lshl_b32 s58, s58, 8
    s_lshl_b32 s64, s53, 4
    s_lshl_b32 s59, s54, 1
    s_add_u32 s64, s64, s59
    s_lshr_b32 s59, s55, 1
    s_add_u32 s64, s64, s59
    s_lshl_b32 s64, s64, 18
    s_mov_b32 s22, 73728
    s_mov_b32 s23, 0x20000
    s_sub_u32 s26, 4718592, s58
    s_mov_b32 s27, 0x20000
    s_mov_b32 s30, 262144
    s_mov_b32 s31, 0x20000
    s_mov_b32 s34, 262144
    s_mov_b32 s35, 0x20000
    s_mov_b32 s42, 0x10000000
    s_mov_b32 s43, 0x20000
    s_cmp_eq_u32 s52, 4
    s_cbranch_scc1 L_ldr
    s_waitcnt lgkmcnt(0)
    v_and_b32 v18, 0x7f, v0
    v_lshrrev_b32 v19, 3, v18
    v_and_b32 v20, 7, v18
    s_lshl_b32 s72, s71, 4
    v_add_u32 v19, s72, v19
    s_cmp_ge_u32 s52, 2
    s_cbranch_scc1 L_tx_c1
    v_add_u32 v19, 64, v19
    v_lshlrev_b32 v19, 13, v19
    v_lshl_add_u32 v19, v20, 7, v19
    s_lshl_b32 s72, s54, 10
    v_add_u32 v19, s72, v19
    global_load_dword v88, v19, s[10:11]
    s_branch L_tj_c2
L_tx_c1:
    v_mul_u32_u24 v19, 1152, v19
    v_lshl_add_u32 v19, v20, 7, v19
    global_load_dword v88, v19, s[4:5] offset:128
L_tj_c2:
    s_cmp_lg_u32 s52, 0
    s_cbranch_scc1 L_pf_c3
    s_lshl_b32 s72, s71, 11
    v_lshlrev_b32 v18, 7, v1
    v_add_u32 v18, s72, v18
    s_mov_b32 s68, L_codeend-L_pcbase
    v_cmp_gt_u32 vcc, s68, v18
    s_and_b64 vcc, vcc, 0xffff
    s_and_saveexec_b64 s[72:73], vcc
    s_cbranch_execz L_pf_c3_r
    global_load_dword v89, v18, s[74:75]
L_pf_c3_r:
    s_mov_b64 exec, s[72:73]
L_pf_c3:
    s_branch L_compute
L_ldr:
L_loader0:
    v_lshrrev_b32 v20, 4, v1
    v_and_b32 v21, 15, v1
    v_lshlrev_b32 v22, 2, v20
    v_xor_b32 v22, v22, v21
    v_lshlrev_b32 v22, 4, v22
    v_lshl_add_u32 v6, v20, 8, v22
    v_lshl_add_u32 v7, v20, 13, v22
    v_lshrrev_b32 v23, 3, v1
    v_and_b32 v24, 7, v1
    v_mul_u32_u24 v23, 1152, v23
    v_add_u32 v22, 0, v20
    v_xor_b32 v22, v22, v24
    v_lshl_add_u32 v8, v22, 4, v23
    v_add_u32 v22, 4, v20
    v_xor_b32 v22, v22, v24
    v_lshl_add_u32 v9, v22, 4, v23
    v_add_u32 v22, 0, v20
    v_xor_b32 v22, v22, v21
    v_lshlrev_b32 v22, 4, v22
    v_lshl_add_u32 v2, v20, 8, v22
    v_add_u32 v22, 4, v20
    v_xor_b32 v22, v22, v21
    v_lshlrev_b32 v22, 4, v22
    v_lshl_add_u32 v3, v20, 8, v22
    v_add_u32 v22, 8, v20
    v_xor_b32 v22, v22, v21
    v_lshlrev_b32 v22, 4, v22
    v_lshl_add_u32 v4, v20, 8, v22
    v_add_u32 v22, 12, v20
    v_xor_b32 v22, v22, v21
    v_lshlrev_b32 v22, 4, v22
    v_lshl_add_u32 v5, v20, 8, v22
    s_waitcnt lgkmcnt(0)
    s_add_u32 s20, s4, s57
    s_addc_u32 s21, s5, 0
    s_add_u32 s24, s10, s58
    s_addc_u32 s25, s11, 0
    s_add_u32 s28, s6, s64
    s_addc_u32 s29, s7, 0
    s_add_u32 s32, s8, s64
    s_addc_u32 s33, s9, 0
    s_mov_b32 s40, s18
    s_mov_b32 s41, s19
    s_mov_b32 m0, 0
    s_mov_b32 s59, 0
    buffer_load_dwordx4 v7, s[24:27], s59 offen offset:0  lds
    s_mov_b32 s59, 31744
    buffer_load_dwordx4 v7, s[24:27], s59 offen offset:1024  lds
    s_mov_b32 s59, 63488
    buffer_load_dwordx4 v7, s[24:27], s59 offen offset:2048  lds
    s_mov_b32 s59, 95232
    buffer_load_dwordx4 v7, s[24:27], s59 offen offset:3072  lds
    s_mov_b32 m0, 4096
    s_mov_b32 s59, 131072
    buffer_load_dwordx4 v7, s[24:27], s59 offen offset:0  lds
    s_mov_b32 s59, 162816
    buffer_load_dwordx4 v7, s[24:27], s59 offen offset:1024  lds
    s_mov_b32 s59, 194560
    buffer_load_dwordx4 v7, s[24:27], s59 offen offset:2048  lds
    s_mov_b32 s59, 226304
    buffer_load_dwordx4 v7, s[24:27], s59 offen offset:3072  lds
    s_mov_b32 m0, 8192
    s_mov_b32 s59, 262144
    buffer_load_dwordx4 v7, s[24:27], s59 offen offset:0  lds
    s_mov_b32 s59, 293888
    buffer_load_dwordx4 v7, s[24:27], s59 offen offset:1024  lds
    s_mov_b32 s59, 325632
    buffer_load_dwordx4 v7, s[24:27], s59 offen offset:2048  lds
    s_mov_b32 s59, 357376
    buffer_load_dwordx4 v7, s[24:27], s59 offen offset:3072  lds
    s_mov_b32 m0, 12288
    s_mov_b32 s59, 393216
    buffer_load_dwordx4 v7, s[24:27], s59 offen offset:0  lds
    s_mov_b32 s59, 424960
    buffer_load_dwordx4 v7, s[24:27], s59 offen offset:1024  lds
    s_mov_b32 s59, 456704
    buffer_load_dwordx4 v7, s[24:27], s59 offen offset:2048  lds
    s_mov_b32 s59, 488448
    buffer_load_dwordx4 v7, s[24:27], s59 offen offset:3072  lds
    s_mov_b32 m0, 16384
    s_mov_b32 s59, 0
    buffer_load_dwordx4 v8, s[20:23], s59 offen offset:0 lds
    s_mov_b32 s59, 8192
    buffer_load_dwordx4 v9, s[20:23], s59 offen offset:1024 lds
    s_mov_b32 s59, 16384
    buffer_load_dwordx4 v8, s[20:23], s59 offen offset:2048 lds
    s_mov_b32 s59, 24576
    buffer_load_dwordx4 v9, s[20:23], s59 offen offset:3072 lds
    s_mov_b32 m0, 20480
    s_mov_b32 s59, 36864
    buffer_load_dwordx4 v8, s[20:23], s59 offen offset:0 lds
    s_mov_b32 s59, 45056
    buffer_load_dwordx4 v9, s[20:23], s59 offen offset:1024 lds
    s_mov_b32 s59, 53248
    buffer_load_dwordx4 v8, s[20:23], s59 offen offset:2048 lds
    s_mov_b32 s59, 61440
    buffer_load_dwordx4 v9, s[20:23], s59 offen offset:3072 lds
    s_getreg_b32 s65, hwreg(HW_REG_XCC_ID)
    s_and_b32 s65, s65, 0xff
    s_add_u32 s65, s65, 1
    s_lshl_b32 s65, s65, 8
    s_mov_b32 m0, 24576
    s_mov_b32 s59, 524288
    buffer_load_dwordx4 v7, s[24:27], s59 offen offset:0  lds
    s_mov_b32 s59, 556032
    buffer_load_dwordx4 v7, s[24:27], s59 offen offset:1024  lds
    s_mov_b32 s59, 587776
    buffer_load_dwordx4 v7, s[24:27], s59 offen offset:2048  lds
    s_mov_b32 s59, 619520
    buffer_load_dwordx4 v7, s[24:27], s59 offen offset:3072  lds
    s_mov_b32 m0, 28672
    s_mov_b32 s59, 655360
    buffer_load_dwordx4 v7, s[24:27], s59 offen offset:0  lds
    s_mov_b32 s59, 687104
    buffer_load_dwordx4 v7, s[24:27], s59 offen offset:1024  lds
    s_mov_b32 s59, 718848
    buffer_load_dwordx4 v7, s[24:27], s59 offen offset:2048  lds
    s_mov_b32 s59, 750592
    buffer_load_dwordx4 v7, s[24:27], s59 offen offset:3072  lds
    s_mov_b32 m0, 32768
    s_mov_b32 s59, 786432
    buffer_load_dwordx4 v7, s[24:27], s59 offen offset:0  lds
    s_mov_b32 s59, 818176
    buffer_load_dwordx4 v7, s[24:27], s59 offen offset:1024  lds
    s_mov_b32 s59, 849920
    buffer_load_dwordx4 v7, s[24:27], s59 offen offset:2048  lds
    s_mov_b32 s59, 881664
    buffer_load_dwordx4 v7, s[24:27], s59 offen offset:3072  lds
    s_mov_b32 m0, 36864
    s_mov_b32 s59, 917504
    buffer_load_dwordx4 v7, s[24:27], s59 offen offset:0  lds
    s_mov_b32 s59, 949248
    buffer_load_dwordx4 v7, s[24:27], s59 offen offset:1024  lds
    s_mov_b32 s59, 980992
    buffer_load_dwordx4 v7, s[24:27], s59 offen offset:2048  lds
    s_mov_b32 s59, 1012736
    buffer_load_dwordx4 v7, s[24:27], s59 offen offset:3072  lds
    s_mov_b32 m0, 40960
    s_mov_b32 s59, 128
    buffer_load_dwordx4 v8, s[20:23], s59 offen offset:0 lds
    s_mov_b32 s59, 8320
    buffer_load_dwordx4 v9, s[20:23], s59 offen offset:1024 lds
    s_mov_b32 s59, 16512
    buffer_load_dwordx4 v8, s[20:23], s59 offen offset:2048 lds
    s_mov_b32 s59, 24704
    buffer_load_dwordx4 v9, s[20:23], s59 offen offset:3072 lds
    s_mov_b32 m0, 45056
    s_mov_b32 s59, 36992
    buffer_load_dwordx4 v8, s[20:23], s59 offen offset:0 lds
    s_mov_b32 s59, 45184
    buffer_load_dwordx4 v9, s[20:23], s59 offen offset:1024 lds
    s_mov_b32 s59, 53376
    buffer_load_dwordx4 v8, s[20:23], s59 offen offset:2048 lds
    s_mov_b32 s59, 61568
    buffer_load_dwordx4 v9, s[20:23], s59 offen offset:3072 lds
    s_mul_i32 s57, s54, 589824
    s_mul_i32 s58, s55, 288
    s_add_u32 s57, s57, s58
    s_add_u32 s36, s12, s57
    s_addc_u32 s37, s13, 0
    s_sub_u32 s38, 4718592, s57
    s_mov_b32 s39, 0x20000
    s_mov_b32 s48, s16
    s_mov_b32 s49, s17
    s_mov_b32 s50, 256
    s_mov_b32 s51, 0x20000
    v_add_u32 v20, 0, v1
    v_mul_u32_u24 v21, 3641, v20
    v_lshrrev_b32 v21, 16, v21
    v_mul_u32_u24 v22, 18, v21
    v_sub_u32 v22, v20, v22
    v_mul_u32_u24 v21, 1152, v21
    v_lshl_add_u32 v21, v22, 4, v21
    v_subrev_u32 v10, 0, v21
    v_add_u32 v20, 64, v1
    v_mul_u32_u24 v21, 3641, v20
    v_lshrrev_b32 v21, 16, v21
    v_mul_u32_u24 v22, 18, v21
    v_sub_u32 v22, v20, v22
    v_mul_u32_u24 v21, 1152, v21
    v_lshl_add_u32 v21, v22, 4, v21
    v_subrev_u32 v11, 1024, v21
    v_add_u32 v20, 128, v1
    v_mul_u32_u24 v21, 3641, v20
    v_lshrrev_b32 v21, 16, v21
    v_mul_u32_u24 v22, 18, v21
    v_sub_u32 v22, v20, v22
    v_mul_u32_u24 v21, 1152, v21
    v_lshl_add_u32 v21, v22, 4, v21
    v_subrev_u32 v12, 2048, v21
    v_add_u32 v20, 192, v1
    v_mul_u32_u24 v21, 3641, v20
    v_lshrrev_b32 v21, 16, v21
    v_mul_u32_u24 v22, 18, v21
    v_sub_u32 v22, v20, v22
    v_mul_u32_u24 v21, 1152, v21
    v_lshl_add_u32 v21, v22, 4, v21
    v_subrev_u32 v13, 3072, v21
    v_add_u32 v20, 256, v1
    v_mul_u32_u24 v21, 3641, v20
    v_lshrrev_b32 v21, 16, v21
    v_mul_u32_u24 v22, 18, v21
    v_sub_u32 v22, v20, v22
    v_mul_u32_u24 v21, 1152, v21
    v_lshl_add_u32 v21, v22, 4, v21
    v_subrev_u32 v14, 0, v21
    v_add_u32 v20, 320, v1
    v_mul_u32_u24 v21, 3641, v20
    v_lshrrev_b32 v21, 16, v21
    v_mul_u32_u24 v22, 18, v21
    v_sub_u32 v22, v20, v22
    v_mul_u32_u24 v21, 1152, v21
    v_lshl_add_u32 v21, v22, 4, v21
    v_subrev_u32 v15, 1024, v21
    v_add_u32 v20, 384, v1
    v_mul_u32_u24 v21, 3641, v20
    v_lshrrev_b32 v21, 16, v21
    v_mul_u32_u24 v22, 18, v21
    v_sub_u32 v22, v20, v22
    v_mul_u32_u24 v21, 1152, v21
    v_lshl_add_u32 v21, v22, 4, v21
    v_subrev_u32 v16, 2048, v21
    v_add_u32 v20, 448, v1
    v_mul_u32_u24 v21, 3641, v20
    v_lshrrev_b32 v21, 16, v21
    v_mul_u32_u24 v22, 18, v21
    v_sub_u32 v22, v20, v22
    v_mul_u32_u24 v21, 1152, v21
    v_lshl_add_u32 v21, v22, 4, v21
    v_subrev_u32 v17, 3072, v21
    v_add_u32 v20, 512, v1
    v_mul_u32_u24 v21, 3641, v20
    v_lshrrev_b32 v21, 16, v21
    v_mul_u32_u24 v22, 18, v21
    v_sub_u32 v22, v20, v22
    v_mul_u32_u24 v21, 1152, v21
    v_lshl_add_u32 v21, v22, 4, v21
    v_subrev_u32 v18, 0, v21
    s_lshl_b32 s57, s56, 7
    v_mov_b32 v24, s57
    v_add_u32 v25, 32768, v24
    s_and_b32 s57, s56, 0xfc
    v_add_u32 v26, s57, v1
    v_lshlrev_b32 v26, 7, v26
    s_lshl_b32 s57, s53, 5
    s_add_u32 s57, s57, s55
    v_lshlrev_b32 v27, 2, v1
    v_add_u32 v27, s57, v27
    v_lshlrev_b32 v27, 7, v27
    v_add_u32 v27, 32768, v27
    s_lshl_b32 s57, s53, 2
    v_mov_b32 v28, s57
    s_waitcnt vmcnt(24)
    s_barrier
    s_mov_b32 m0, 49152
    s_mov_b32 s59, 1048576
    buffer_load_dwordx4 v7, s[24:27], s59 offen offset:0  lds
    s_mov_b32 s59, 1080320
    buffer_load_dwordx4 v7, s[24:27], s59 offen offset:1024  lds
    s_mov_b32 s59, 1112064
    buffer_load_dwordx4 v7, s[24:27], s59 offen offset:2048  lds
    s_mov_b32 s59, 1143808
    buffer_load_dwordx4 v7, s[24:27], s59 offen offset:3072  lds
    s_mov_b32 m0, 53248
    s_mov_b32 s59, 1179648
    buffer_load_dwordx4 v7, s[24:27], s59 offen offset:0  lds
    s_mov_b32 s59, 1211392
    buffer_load_dwordx4 v7, s[24:27], s59 offen offset:1024  lds
    s_mov_b32 s59, 1243136
    buffer_load_dwordx4 v7, s[24:27], s59 offen offset:2048  lds
    s_mov_b32 s59, 1274880
    buffer_load_dwordx4 v7, s[24:27], s59 offen offset:3072  lds
    s_mov_b32 m0, 57344
    s_mov_b32 s59, 1310720
    buffer_load_dwordx4 v7, s[24:27], s59 offen offset:0  lds
    s_mov_b32 s59, 1342464
    buffer_load_dwordx4 v7, s[24:27], s59 offen offset:1024  lds
    s_mov_b32 s59, 1374208
    buffer_load_dwordx4 v7, s[24:27], s59 offen offset:2048  lds
    s_mov_b32 s59, 1405952
    buffer_load_dwordx4 v7, s[24:27], s59 offen offset:3072  lds
    s_mov_b32 m0, 61440
    s_mov_b32 s59, 1441792
    buffer_load_dwordx4 v7, s[24:27], s59 offen offset:0  lds
    s_mov_b32 s59, 1473536
    buffer_load_dwordx4 v7, s[24:27], s59 offen offset:1024  lds
    s_mov_b32 s59, 1505280
    buffer_load_dwordx4 v7, s[24:27], s59 offen offset:2048  lds
    s_mov_b32 s59, 1537024
    buffer_load_dwordx4 v7, s[24:27], s59 offen offset:3072  lds
    s_mov_b32 m0, 65536
    s_mov_b32 s59, 256
    buffer_load_dwordx4 v8, s[20:23], s59 offen offset:0 lds
    s_mov_b32 s59, 8448
    buffer_load_dwordx4 v9, s[20:23], s59 offen offset:1024 lds
    s_mov_b32 s59, 16640
    buffer_load_dwordx4 v8, s[20:23], s59 offen offset:2048 lds
    s_mov_b32 s59, 24832
    buffer_load_dwordx4 v9, s[20:23], s59 offen offset:3072 lds
    s_mov_b32 m0, 69632
    s_mov_b32 s59, 37120
    buffer_load_dwordx4 v8, s[20:23], s59 offen offset:0 lds
    s_mov_b32 s59, 45312
    buffer_load_dwordx4 v9, s[20:23], s59 offen offset:1024 lds
    s_mov_b32 s59, 53504
    buffer_load_dwordx4 v8, s[20:23], s59 offen offset:2048 lds
    s_mov_b32 s59, 61696
    buffer_load_dwordx4 v9, s[20:23], s59 offen offset:3072 lds
    s_waitcnt vmcnt(24)
    s_barrier
    s_mov_b32 m0, 0
    s_mov_b32 s59, 1572864
    buffer_load_dwordx4 v7, s[24:27], s59 offen offset:0  lds
    s_mov_b32 s59, 1604608
    buffer_load_dwordx4 v7, s[24:27], s59 offen offset:1024  lds
    s_mov_b32 s59, 1636352
    buffer_load_dwordx4 v7, s[24:27], s59 offen offset:2048  lds
    s_mov_b32 s59, 1668096
    buffer_load_dwordx4 v7, s[24:27], s59 offen offset:3072  lds
    s_mov_b32 m0, 4096
    s_mov_b32 s59, 1703936
    buffer_load_dwordx4 v7, s[24:27], s59 offen offset:0  lds
    s_mov_b32 s59, 1735680
    buffer_load_dwordx4 v7, s[24:27], s59 offen offset:1024  lds
    s_mov_b32 s59, 1767424
    buffer_load_dwordx4 v7, s[24:27], s59 offen offset:2048  lds
    s_mov_b32 s59, 1799168
    buffer_load_dwordx4 v7, s[24:27], s59 offen offset:3072  lds
    s_mov_b32 m0, 8192
    s_mov_b32 s59, 1835008
    buffer_load_dwordx4 v7, s[24:27], s59 offen offset:0  lds
    s_mov_b32 s59, 1866752
    buffer_load_dwordx4 v7, s[24:27], s59 offen offset:1024  lds
    s_mov_b32 s59, 1898496
    buffer_load_dwordx4 v7, s[24:27], s59 offen offset:2048  lds
    s_mov_b32 s59, 1930240
    buffer_load_dwordx4 v7, s[24:27], s59 offen offset:3072  lds
    s_mov_b32 m0, 12288
    s_mov_b32 s59, 1966080
    buffer_load_dwordx4 v7, s[24:27], s59 offen offset:0  lds
    s_mov_b32 s59, 1997824
    buffer_load_dwordx4 v7, s[24:27], s59 offen offset:1024  lds
    s_mov_b32 s59, 2029568
    buffer_load_dwordx4 v7, s[24:27], s59 offen offset:2048  lds
    s_mov_b32 s59, 2061312
    buffer_load_dwordx4 v7, s[24:27], s59 offen offset:3072  lds
    s_mov_b32 m0, 16384
    s_mov_b32 s59, 384
    buffer_load_dwordx4 v8, s[20:23], s59 offen offset:0 lds
    s_mov_b32 s59, 8576
    buffer_load_dwordx4 v9, s[20:23], s59 offen offset:1024 lds
    s_mov_b32 s59, 16768
    buffer_load_dwordx4 v8, s[20:23], s59 offen offset:2048 lds
    s_mov_b32 s59, 24960
    buffer_load_dwordx4 v9, s[20:23], s59 offen offset:3072 lds
    s_mov_b32 m0, 20480
    s_mov_b32 s59, 37248
    buffer_load_dwordx4 v8, s[20:23], s59 offen offset:0 lds
    s_mov_b32 s59, 45440
    buffer_load_dwordx4 v9, s[20:23], s59 offen offset:1024 lds
    s_mov_b32 s59, 53632
    buffer_load_dwordx4 v8, s[20:23], s59 offen offset:2048 lds
    s_mov_b32 s59, 61824
    buffer_load_dwordx4 v9, s[20:23], s59 offen offset:3072 lds
    s_waitcnt vmcnt(24)
    s_barrier
    s_mov_b32 m0, 24576
    s_mov_b32 s59, 2097152
    buffer_load_dwordx4 v7, s[24:27], s59 offen offset:0  lds
    s_mov_b32 s59, 2128896
    buffer_load_dwordx4 v7, s[24:27], s59 offen offset:1024  lds
    s_mov_b32 s59, 2160640
    buffer_load_dwordx4 v7, s[24:27], s59 offen offset:2048  lds
    s_mov_b32 s59, 2192384
    buffer_load_dwordx4 v7, s[24:27], s59 offen offset:3072  lds
    s_mov_b32 m0, 28672
    s_mov_b32 s59, 2228224
    buffer_load_dwordx4 v7, s[24:27], s59 offen offset:0  lds
    s_mov_b32 s59, 2259968
    buffer_load_dwordx4 v7, s[24:27], s59 offen offset:1024  lds
    s_mov_b32 s59, 2291712
    buffer_load_dwordx4 v7, s[24:27], s59 offen offset:2048  lds
    s_mov_b32 s59, 2323456
    buffer_load_dwordx4 v7, s[24:27], s59 offen offset:3072  lds
    s_mov_b32 m0, 32768
    s_mov_b32 s59, 2359296
    buffer_load_dwordx4 v7, s[24:27], s59 offen offset:0  lds
    s_mov_b32 s59, 2391040
    buffer_load_dwordx4 v7, s[24:27], s59 offen offset:1024  lds
    s_mov_b32 s59, 2422784
    buffer_load_dwordx4 v7, s[24:27], s59 offen offset:2048  lds
    s_mov_b32 s59, 2454528
    buffer_load_dwordx4 v7, s[24:27], s59 offen offset:3072  lds
    s_mov_b32 m0, 36864
    s_mov_b32 s59, 2490368
    buffer_load_dwordx4 v7, s[24:27], s59 offen offset:0  lds
    s_mov_b32 s59, 2522112
    buffer_load_dwordx4 v7, s[24:27], s59 offen offset:1024  lds
    s_mov_b32 s59, 2553856
    buffer_load_dwordx4 v7, s[24:27], s59 offen offset:2048  lds
    s_mov_b32 s59, 2585600
    buffer_load_dwordx4 v7, s[24:27], s59 offen offset:3072  lds
    s_mov_b32 m0, 40960
    s_mov_b32 s59, 512
    buffer_load_dwordx4 v8, s[20:23], s59 offen offset:0 lds
    s_mov_b32 s59, 8704
    buffer_load_dwordx4 v9, s[20:23], s59 offen offset:1024 lds
    s_mov_b32 s59, 16896
    buffer_load_dwordx4 v8, s[20:23], s59 offen offset:2048 lds
    s_mov_b32 s59, 25088
    buffer_load_dwordx4 v9, s[20:23], s59 offen offset:3072 lds
    s_mov_b32 m0, 45056
    s_mov_b32 s59, 37376
    buffer_load_dwordx4 v8, s[20:23], s59 offen offset:0 lds
    s_mov_b32 s59, 45568
    buffer_load_dwordx4 v9, s[20:23], s59 offen offset:1024 lds
    s_mov_b32 s59, 53760
    buffer_load_dwordx4 v8, s[20:23], s59 offen offset:2048 lds
    s_mov_b32 s59, 61952
    buffer_load_dwordx4 v9, s[20:23], s59 offen offset:3072 lds
    s_waitcnt vmcnt(24)
    s_barrier
    s_mov_b32 m0, 49152
    s_mov_b32 s59, 2621440
    buffer_load_dwordx4 v7, s[24:27], s59 offen offset:0  lds
    s_mov_b32 s59, 2653184
    buffer_load_dwordx4 v7, s[24:27], s59 offen offset:1024  lds
    s_mov_b32 s59, 2684928
    buffer_load_dwordx4 v7, s[24:27], s59 offen offset:2048  lds
    s_mov_b32 s59, 2716672
    buffer_load_dwordx4 v7, s[24:27], s59 offen offset:3072  lds
    s_mov_b32 m0, 53248
    s_mov_b32 s59, 2752512
    buffer_load_dwordx4 v7, s[24:27], s59 offen offset:0  lds
    s_mov_b32 s59, 2784256
    buffer_load_dwordx4 v7, s[24:27], s59 offen offset:1024  lds
    s_mov_b32 s59, 2816000
    buffer_load_dwordx4 v7, s[24:27], s59 offen offset:2048  lds
    s_mov_b32 s59, 2847744
    buffer_load_dwordx4 v7, s[24:27], s59 offen offset:3072  lds
    s_mov_b32 m0, 57344
    s_mov_b32 s59, 2883584
    buffer_load_dwordx4 v7, s[24:27], s59 offen offset:0  lds
    s_mov_b32 s59, 2915328
    buffer_load_dwordx4 v7, s[24:27], s59 offen offset:1024  lds
    s_mov_b32 s59, 2947072
    buffer_load_dwordx4 v7, s[24:27], s59 offen offset:2048  lds
    s_mov_b32 s59, 2978816
    buffer_load_dwordx4 v7, s[24:27], s59 offen offset:3072  lds
    s_mov_b32 m0, 61440
    s_mov_b32 s59, 3014656
    buffer_load_dwordx4 v7, s[24:27], s59 offen offset:0  lds
    s_mov_b32 s59, 3046400
    buffer_load_dwordx4 v7, s[24:27], s59 offen offset:1024  lds
    s_mov_b32 s59, 3078144
    buffer_load_dwordx4 v7, s[24:27], s59 offen offset:2048  lds
    s_mov_b32 s59, 3109888
    buffer_load_dwordx4 v7, s[24:27], s59 offen offset:3072  lds
    s_mov_b32 m0, 65536
    s_mov_b32 s59, 640
    buffer_load_dwordx4 v8, s[20:23], s59 offen offset:0 lds
    s_mov_b32 s59, 8832
    buffer_load_dwordx4 v9, s[20:23], s59 offen offset:1024 lds
    s_mov_b32 s59, 17024
    buffer_load_dwordx4 v8, s[20:23], s59 offen offset:2048 lds
    s_mov_b32 s59, 25216
    buffer_load_dwordx4 v9, s[20:23], s59 offen offset:3072 lds
    s_mov_b32 m0, 69632
    s_mov_b32 s59, 37504
    buffer_load_dwordx4 v8, s[20:23], s59 offen offset:0 lds
    s_mov_b32 s59, 45696
    buffer_load_dwordx4 v9, s[20:23], s59 offen offset:1024 lds
    s_mov_b32 s59, 53888
    buffer_load_dwordx4 v8, s[20:23], s59 offen offset:2048 lds
    s_mov_b32 s59, 62080
    buffer_load_dwordx4 v9, s[20:23], s59 offen offset:3072 lds
    s_waitcnt vmcnt(24)
    s_barrier
    s_mov_b32 m0, 0
    s_mov_b32 s59, 3145728
    buffer_load_dwordx4 v7, s[24:27], s59 offen offset:0  lds
    s_mov_b32 s59, 3177472
    buffer_load_dwordx4 v7, s[24:27], s59 offen offset:1024  lds
    s_mov_b32 s59, 3209216
    buffer_load_dwordx4 v7, s[24:27], s59 offen offset:2048  lds
    s_mov_b32 s59, 3240960
    buffer_load_dwordx4 v7, s[24:27], s59 offen offset:3072  lds
    s_mov_b32 m0, 4096
    s_mov_b32 s59, 3276800
    buffer_load_dwordx4 v7, s[24:27], s59 offen offset:0  lds
    s_mov_b32 s59, 3308544
    buffer_load_dwordx4 v7, s[24:27], s59 offen offset:1024  lds
    s_mov_b32 s59, 3340288
    buffer_load_dwordx4 v7, s[24:27], s59 offen offset:2048  lds
    s_mov_b32 s59, 3372032
    buffer_load_dwordx4 v7, s[24:27], s59 offen offset:3072  lds
    s_mov_b32 m0, 8192
    s_mov_b32 s59, 3407872
    buffer_load_dwordx4 v7, s[24:27], s59 offen offset:0  lds
    s_mov_b32 s59, 3439616
    buffer_load_dwordx4 v7, s[24:27], s59 offen offset:1024  lds
    s_mov_b32 s59, 3471360
    buffer_load_dwordx4 v7, s[24:27], s59 offen offset:2048  lds
    s_mov_b32 s59, 3503104
    buffer_load_dwordx4 v7, s[24:27], s59 offen offset:3072  lds
    s_mov_b32 m0, 12288
    s_mov_b32 s59, 3538944
    buffer_load_dwordx4 v7, s[24:27], s59 offen offset:0  lds
    s_mov_b32 s59, 3570688
    buffer_load_dwordx4 v7, s[24:27], s59 offen offset:1024  lds
    s_mov_b32 s59, 3602432
    buffer_load_dwordx4 v7, s[24:27], s59 offen offset:2048  lds
    s_mov_b32 s59, 3634176
    buffer_load_dwordx4 v7, s[24:27], s59 offen offset:3072  lds
    s_mov_b32 m0, 16384
    s_mov_b32 s59, 768
    buffer_load_dwordx4 v8, s[20:23], s59 offen offset:0 lds
    s_mov_b32 s59, 8960
    buffer_load_dwordx4 v9, s[20:23], s59 offen offset:1024 lds
    s_mov_b32 s59, 17152
    buffer_load_dwordx4 v8, s[20:23], s59 offen offset:2048 lds
    s_mov_b32 s59, 25344
    buffer_load_dwordx4 v9, s[20:23], s59 offen offset:3072 lds
    s_mov_b32 m0, 20480
    s_mov_b32 s59, 37632
    buffer_load_dwordx4 v8, s[20:23], s59 offen offset:0 lds
    s_mov_b32 s59, 45824
    buffer_load_dwordx4 v9, s[20:23], s59 offen offset:1024 lds
    s_mov_b32 s59, 54016
    buffer_load_dwordx4 v8, s[20:23], s59 offen offset:2048 lds
    s_mov_b32 s59, 62208
    buffer_load_dwordx4 v9, s[20:23], s59 offen offset:3072 lds
    s_waitcnt vmcnt(24)
    s_barrier
    s_mov_b32 m0, 24576
    s_mov_b32 s59, 3670016
    buffer_load_dwordx4 v7, s[24:27], s59 offen offset:0  lds
    s_mov_b32 s59, 3701760
    buffer_load_dwordx4 v7, s[24:27], s59 offen offset:1024  lds
    s_mov_b32 s59, 3733504
    buffer_load_dwordx4 v7, s[24:27], s59 offen offset:2048  lds
    s_mov_b32 s59, 3765248
    buffer_load_dwordx4 v7, s[24:27], s59 offen offset:3072  lds
    s_mov_b32 m0, 28672
    s_mov_b32 s59, 3801088
    buffer_load_dwordx4 v7, s[24:27], s59 offen offset:0  lds
    s_mov_b32 s59, 3832832
    buffer_load_dwordx4 v7, s[24:27], s59 offen offset:1024  lds
    s_mov_b32 s59, 3864576
    buffer_load_dwordx4 v7, s[24:27], s59 offen offset:2048  lds
    s_mov_b32 s59, 3896320
    buffer_load_dwordx4 v7, s[24:27], s59 offen offset:3072  lds
    s_mov_b32 m0, 32768
    s_mov_b32 s59, 3932160
    buffer_load_dwordx4 v7, s[24:27], s59 offen offset:0  lds
    s_mov_b32 s59, 3963904
    buffer_load_dwordx4 v7, s[24:27], s59 offen offset:1024  lds
    s_mov_b32 s59, 3995648
    buffer_load_dwordx4 v7, s[24:27], s59 offen offset:2048  lds
    s_mov_b32 s59, 4027392
    buffer_load_dwordx4 v7, s[24:27], s59 offen offset:3072  lds
    s_mov_b32 m0, 36864
    s_mov_b32 s59, 4063232
    buffer_load_dwordx4 v7, s[24:27], s59 offen offset:0  lds
    s_mov_b32 s59, 4094976
    buffer_load_dwordx4 v7, s[24:27], s59 offen offset:1024  lds
    s_mov_b32 s59, 4126720
    buffer_load_dwordx4 v7, s[24:27], s59 offen offset:2048  lds
    s_mov_b32 s59, 4158464
    buffer_load_dwordx4 v7, s[24:27], s59 offen offset:3072  lds
    s_mov_b32 m0, 40960
    s_mov_b32 s59, 896
    buffer_load_dwordx4 v8, s[20:23], s59 offen offset:0 lds
    s_mov_b32 s59, 9088
    buffer_load_dwordx4 v9, s[20:23], s59 offen offset:1024 lds
    s_mov_b32 s59, 17280
    buffer_load_dwordx4 v8, s[20:23], s59 offen offset:2048 lds
    s_mov_b32 s59, 25472
    buffer_load_dwordx4 v9, s[20:23], s59 offen offset:3072 lds
    s_mov_b32 m0, 45056
    s_mov_b32 s59, 37760
    buffer_load_dwordx4 v8, s[20:23], s59 offen offset:0 lds
    s_mov_b32 s59, 45952
    buffer_load_dwordx4 v9, s[20:23], s59 offen offset:1024 lds
    s_mov_b32 s59, 54144
    buffer_load_dwordx4 v8, s[20:23], s59 offen offset:2048 lds
    s_mov_b32 s59, 62336
    buffer_load_dwordx4 v9, s[20:23], s59 offen offset:3072 lds
    s_waitcnt vmcnt(24)
    s_barrier
    s_mov_b32 m0, 49152
    s_mov_b32 s59, 4194304
    buffer_load_dwordx4 v7, s[24:27], s59 offen offset:0  lds
    s_mov_b32 s59, 4226048
    buffer_load_dwordx4 v7, s[24:27], s59 offen offset:1024  lds
    s_mov_b32 s59, 4257792
    buffer_load_dwordx4 v7, s[24:27], s59 offen offset:2048  lds
    s_mov_b32 s59, 4289536
    buffer_load_dwordx4 v7, s[24:27], s59 offen offset:3072  lds
    s_mov_b32 m0, 53248
    s_mov_b32 s59, 4325376
    buffer_load_dwordx4 v7, s[24:27], s59 offen offset:0  lds
    s_mov_b32 s59, 4357120
    buffer_load_dwordx4 v7, s[24:27], s59 offen offset:1024  lds
    s_mov_b32 s59, 4388864
    buffer_load_dwordx4 v7, s[24:27], s59 offen offset:2048  lds
    s_mov_b32 s59, 4420608
    buffer_load_dwordx4 v7, s[24:27], s59 offen offset:3072  lds
    s_mov_b32 m0, 57344
    s_mov_b32 s59, 4456448
    buffer_load_dwordx4 v7, s[24:27], s59 offen offset:0  lds
    s_mov_b32 s59, 4488192
    buffer_load_dwordx4 v7, s[24:27], s59 offen offset:1024  lds
    s_mov_b32 s59, 4519936
    buffer_load_dwordx4 v7, s[24:27], s59 offen offset:2048  lds
    s_mov_b32 s59, 4551680
    buffer_load_dwordx4 v7, s[24:27], s59 offen offset:3072  lds
    s_mov_b32 m0, 61440
    s_mov_b32 s59, 4587520
    buffer_load_dwordx4 v7, s[24:27], s59 offen offset:0  lds
    s_mov_b32 s59, 4619264
    buffer_load_dwordx4 v7, s[24:27], s59 offen offset:1024  lds
    s_mov_b32 s59, 4651008
    buffer_load_dwordx4 v7, s[24:27], s59 offen offset:2048  lds
    s_mov_b32 s59, 4682752
    buffer_load_dwordx4 v7, s[24:27], s59 offen offset:3072  lds
    s_mov_b32 m0, 65536
    s_mov_b32 s59, 1024
    buffer_load_dwordx4 v8, s[20:23], s59 offen offset:0 lds
    s_mov_b32 s59, 9216
    buffer_load_dwordx4 v9, s[20:23], s59 offen offset:1024 lds
    s_mov_b32 s59, 17408
    buffer_load_dwordx4 v8, s[20:23], s59 offen offset:2048 lds
    s_mov_b32 s59, 25600
    buffer_load_dwordx4 v9, s[20:23], s59 offen offset:3072 lds
    s_mov_b32 m0, 69632
    s_mov_b32 s59, 37888
    buffer_load_dwordx4 v8, s[20:23], s59 offen offset:0 lds
    s_mov_b32 s59, 46080
    buffer_load_dwordx4 v9, s[20:23], s59 offen offset:1024 lds
    s_mov_b32 s59, 54272
    buffer_load_dwordx4 v8, s[20:23], s59 offen offset:2048 lds
    s_mov_b32 s59, 62464
    buffer_load_dwordx4 v9, s[20:23], s59 offen offset:3072 lds
    s_mov_b32 m0, 81920
    s_mov_b32 s59, 0
    buffer_load_dwordx4 v2, s[28:31], s59 offen offset:0 nt lds
    buffer_load_dwordx4 v3, s[28:31], s59 offen offset:1024 nt lds
    buffer_load_dwordx4 v4, s[28:31], s59 offen offset:2048 nt lds
    buffer_load_dwordx4 v5, s[28:31], s59 offen offset:3072 nt lds
    s_mov_b32 m0, 86016
    s_mov_b32 s59, 4096
    buffer_load_dwordx4 v2, s[28:31], s59 offen offset:0 nt lds
    buffer_load_dwordx4 v3, s[28:31], s59 offen offset:1024 nt lds
    buffer_load_dwordx4 v4, s[28:31], s59 offen offset:2048 nt lds
    buffer_load_dwordx4 v5, s[28:31], s59 offen offset:3072 nt lds
    s_mov_b32 m0, 90112
    s_mov_b32 s59, 8192
    buffer_load_dwordx4 v2, s[28:31], s59 offen offset:0 nt lds
    buffer_load_dwordx4 v3, s[28:31], s59 offen offset:1024 nt lds
    buffer_load_dwordx4 v4, s[28:31], s59 offen offset:2048 nt lds
    buffer_load_dwordx4 v5, s[28:31], s59 offen offset:3072 nt lds
    s_mov_b32 m0, 94208
    s_mov_b32 s59, 12288
    buffer_load_dwordx4 v2, s[28:31], s59 offen offset:0 nt lds
    buffer_load_dwordx4 v3, s[28:31], s59 offen offset:1024 nt lds
    buffer_load_dwordx4 v4, s[28:31], s59 offen offset:2048 nt lds
    buffer_load_dwordx4 v5, s[28:31], s59 offen offset:3072 nt lds
    s_mov_b32 m0, 98304
    s_mov_b32 s59, 16384
    buffer_load_dwordx4 v2, s[28:31], s59 offen offset:0 nt lds
    buffer_load_dwordx4 v3, s[28:31], s59 offen offset:1024 nt lds
    buffer_load_dwordx4 v4, s[28:31], s59 offen offset:2048 nt lds
    buffer_load_dwordx4 v5, s[28:31], s59 offen offset:3072 nt lds
    s_mov_b32 m0, 102400
    s_mov_b32 s59, 20480
    buffer_load_dwordx4 v2, s[28:31], s59 offen offset:0 nt lds
    buffer_load_dwordx4 v3, s[28:31], s59 offen offset:1024 nt lds
    buffer_load_dwordx4 v4, s[28:31], s59 offen offset:2048 nt lds
    buffer_load_dwordx4 v5, s[28:31], s59 offen offset:3072 nt lds
    s_mov_b32 m0, 106496
    s_mov_b32 s59, 24576
    buffer_load_dwordx4 v2, s[28:31], s59 offen offset:0 nt lds
    buffer_load_dwordx4 v3, s[28:31], s59 offen offset:1024 nt lds
    buffer_load_dwordx4 v4, s[28:31], s59 offen offset:2048 nt lds
    buffer_load_dwordx4 v5, s[28:31], s59 offen offset:3072 nt lds
    s_mov_b32 m0, 110592
    s_mov_b32 s59, 28672
    buffer_load_dwordx4 v2, s[28:31], s59 offen offset:0 nt lds
    buffer_load_dwordx4 v3, s[28:31], s59 offen offset:1024 nt lds
    buffer_load_dwordx4 v4, s[28:31], s59 offen offset:2048 nt lds
    buffer_load_dwordx4 v5, s[28:31], s59 offen offset:3072 nt lds
    s_mov_b32 m0, 114688
    s_mov_b32 s59, 0
    buffer_load_dwordx4 v6, s[32:35], s59 offen offset:0 nt lds
    buffer_load_dwordx4 v6, s[32:35], s59 offen offset:1024 nt lds
    buffer_load_dwordx4 v6, s[32:35], s59 offen offset:2048 nt lds
    buffer_load_dwordx4 v6, s[32:35], s59 offen offset:3072 nt lds
    s_mov_b32 m0, 118784
    s_mov_b32 s59, 4096
    buffer_load_dwordx4 v6, s[32:35], s59 offen offset:0 nt lds
    buffer_load_dwordx4 v6, s[32:35], s59 offen offset:1024 nt lds
    buffer_load_dwordx4 v6, s[32:35], s59 offen offset:2048 nt lds
    buffer_load_dwordx4 v6, s[32:35], s59 offen offset:3072 nt lds
    s_mov_b32 m0, 122880
    s_mov_b32 s59, 8192
    buffer_load_dwordx4 v6, s[32:35], s59 offen offset:0 nt lds
    buffer_load_dwordx4 v6, s[32:35], s59 offen offset:1024 nt lds
    buffer_load_dwordx4 v6, s[32:35], s59 offen offset:2048 nt lds
    buffer_load_dwordx4 v6, s[32:35], s59 offen offset:3072 nt lds
    s_mov_b32 m0, 126976
    s_mov_b32 s59, 12288
    buffer_load_dwordx4 v6, s[32:35], s59 offen offset:0 nt lds
    buffer_load_dwordx4 v6, s[32:35], s59 offen offset:1024 nt lds
    buffer_load_dwordx4 v6, s[32:35], s59 offen offset:2048 nt lds
    buffer_load_dwordx4 v6, s[32:35], s59 offen offset:3072 nt lds
    s_waitcnt vmcnt(63)
    s_barrier
    s_waitcnt vmcnt(48)
    s_barrier
    s_barrier
    s_barrier
    s_waitcnt vmcnt(16)
    s_barrier
    s_mov_b32 m0, 131072
    s_mov_b32 s59, 32768
    buffer_load_dwordx4 v2, s[28:31], s59 offen offset:0 nt lds
    buffer_load_dwordx4 v3, s[28:31], s59 offen offset:1024 nt lds
    buffer_load_dwordx4 v4, s[28:31], s59 offen offset:2048 nt lds
    buffer_load_dwordx4 v5, s[28:31], s59 offen offset:3072 nt lds
    s_mov_b32 m0, 135168
    s_mov_b32 s59, 36864
    buffer_load_dwordx4 v2, s[28:31], s59 offen offset:0 nt lds
    buffer_load_dwordx4 v3, s[28:31], s59 offen offset:1024 nt lds
    buffer_load_dwordx4 v4, s[28:31], s59 offen offset:2048 nt lds
    buffer_load_dwordx4 v5, s[28:31], s59 offen offset:3072 nt lds
    s_mov_b32 m0, 139264
    s_mov_b32 s59, 40960
    buffer_load_dwordx4 v2, s[28:31], s59 offen offset:0 nt lds
    buffer_load_dwordx4 v3, s[28:31], s59 offen offset:1024 nt lds
    buffer_load_dwordx4 v4, s[28:31], s59 offen offset:2048 nt lds
    buffer_load_dwordx4 v5, s[28:31], s59 offen offset:3072 nt lds
    s_mov_b32 m0, 143360
    s_mov_b32 s59, 45056
    buffer_load_dwordx4 v2, s[28:31], s59 offen offset:0 nt lds
    buffer_load_dwordx4 v3, s[28:31], s59 offen offset:1024 nt lds
    buffer_load_dwordx4 v4, s[28:31], s59 offen offset:2048 nt lds
    buffer_load_dwordx4 v5, s[28:31], s59 offen offset:3072 nt lds
    s_mov_b32 m0, 147456
    s_mov_b32 s59, 16384
    buffer_load_dwordx4 v6, s[32:35], s59 offen offset:0 nt lds
    buffer_load_dwordx4 v6, s[32:35], s59 offen offset:1024 nt lds
    buffer_load_dwordx4 v6, s[32:35], s59 offen offset:2048 nt lds
    buffer_load_dwordx4 v6, s[32:35], s59 offen offset:3072 nt lds
    s_mov_b32 m0, 151552
    s_mov_b32 s59, 20480
    buffer_load_dwordx4 v6, s[32:35], s59 offen offset:0 nt lds
    buffer_load_dwordx4 v6, s[32:35], s59 offen offset:1024 nt lds
    buffer_load_dwordx4 v6, s[32:35], s59 offen offset:2048 nt lds
    buffer_load_dwordx4 v6, s[32:35], s59 offen offset:3072 nt lds
    s_mov_b32 m0, 155648
    s_mov_b32 s59, 24576
    buffer_load_dwordx4 v6, s[32:35], s59 offen offset:0 nt lds
    buffer_load_dwordx4 v6, s[32:35], s59 offen offset:1024 nt lds
    buffer_load_dwordx4 v6, s[32:35], s59 offen offset:2048 nt lds
    buffer_load_dwordx4 v6, s[32:35], s59 offen offset:3072 nt lds
    s_mov_b32 m0, 159744
    s_mov_b32 s59, 28672
    buffer_load_dwordx4 v6, s[32:35], s59 offen offset:0 nt lds
    buffer_load_dwordx4 v6, s[32:35], s59 offen offset:1024 nt lds
    buffer_load_dwordx4 v6, s[32:35], s59 offen offset:2048 nt lds
    buffer_load_dwordx4 v6, s[32:35], s59 offen offset:3072 nt lds
    s_mov_b32 m0, 0
    s_mov_b32 s59, 49152
    buffer_load_dwordx4 v2, s[28:31], s59 offen offset:0 nt lds
    buffer_load_dwordx4 v3, s[28:31], s59 offen offset:1024 nt lds
    buffer_load_dwordx4 v4, s[28:31], s59 offen offset:2048 nt lds
    buffer_load_dwordx4 v5, s[28:31], s59 offen offset:3072 nt lds
    s_mov_b32 m0, 4096
    s_mov_b32 s59, 53248
    buffer_load_dwordx4 v2, s[28:31], s59 offen offset:0 nt lds
    buffer_load_dwordx4 v3, s[28:31], s59 offen offset:1024 nt lds
    buffer_load_dwordx4 v4, s[28:31], s59 offen offset:2048 nt lds
    buffer_load_dwordx4 v5, s[28:31], s59 offen offset:3072 nt lds
    s_mov_b32 m0, 8192
    s_mov_b32 s59, 57344
    buffer_load_dwordx4 v2, s[28:31], s59 offen offset:0 nt lds
    buffer_load_dwordx4 v3, s[28:31], s59 offen offset:1024 nt lds
    buffer_load_dwordx4 v4, s[28:31], s59 offen offset:2048 nt lds
    buffer_load_dwordx4 v5, s[28:31], s59 offen offset:3072 nt lds
    s_mov_b32 m0, 12288
    s_mov_b32 s59, 61440
    buffer_load_dwordx4 v2, s[28:31], s59 offen offset:0 nt lds
    buffer_load_dwordx4 v3, s[28:31], s59 offen offset:1024 nt lds
    buffer_load_dwordx4 v4, s[28:31], s59 offen offset:2048 nt lds
    buffer_load_dwordx4 v5, s[28:31], s59 offen offset:3072 nt lds
    s_mov_b32 m0, 16384
    s_mov_b32 s59, 32768
    buffer_load_dwordx4 v6, s[32:35], s59 offen offset:0 nt lds
    buffer_load_dwordx4 v6, s[32:35], s59 offen offset:1024 nt lds
    buffer_load_dwordx4 v6, s[32:35], s59 offen offset:2048 nt lds
    buffer_load_dwordx4 v6, s[32:35], s59 offen offset:3072 nt lds
    s_mov_b32 m0, 20480
    s_mov_b32 s59, 36864
    buffer_load_dwordx4 v6, s[32:35], s59 offen offset:0 nt lds
    buffer_load_dwordx4 v6, s[32:35], s59 offen offset:1024 nt lds
    buffer_load_dwordx4 v6, s[32:35], s59 offen offset:2048 nt lds
    buffer_load_dwordx4 v6, s[32:35], s59 offen offset:3072 nt lds
    s_mov_b32 m0, 24576
    s_mov_b32 s59, 40960
    buffer_load_dwordx4 v6, s[32:35], s59 offen offset:0 nt lds
    buffer_load_dwordx4 v6, s[32:35], s59 offen offset:1024 nt lds
    buffer_load_dwordx4 v6, s[32:35], s59 offen offset:2048 nt lds
    buffer_load_dwordx4 v6, s[32:35], s59 offen offset:3072 nt lds
    s_mov_b32 m0, 28672
    s_mov_b32 s59, 45056
    buffer_load_dwordx4 v6, s[32:35], s59 offen offset:0 nt lds
    buffer_load_dwordx4 v6, s[32:35], s59 offen offset:1024 nt lds
    buffer_load_dwordx4 v6, s[32:35], s59 offen offset:2048 nt lds
    buffer_load_dwordx4 v6, s[32:35], s59 offen offset:3072 nt lds
    s_waitcnt vmcnt(48)
    s_barrier
    s_mov_b32 m0, 32768
    s_mov_b32 s59, 65536
    buffer_load_dwordx4 v2, s[28:31], s59 offen offset:0 nt lds
    buffer_load_dwordx4 v3, s[28:31], s59 offen offset:1024 nt lds
    buffer_load_dwordx4 v4, s[28:31], s59 offen offset:2048 nt lds
    buffer_load_dwordx4 v5, s[28:31], s59 offen offset:3072 nt lds
    s_mov_b32 m0, 36864
    s_mov_b32 s59, 69632
    buffer_load_dwordx4 v2, s[28:31], s59 offen offset:0 nt lds
    buffer_load_dwordx4 v3, s[28:31], s59 offen offset:1024 nt lds
    buffer_load_dwordx4 v4, s[28:31], s59 offen offset:2048 nt lds
    buffer_load_dwordx4 v5, s[28:31], s59 offen offset:3072 nt lds
    s_mov_b32 m0, 40960
    s_mov_b32 s59, 73728
    buffer_load_dwordx4 v2, s[28:31], s59 offen offset:0 nt lds
    buffer_load_dwordx4 v3, s[28:31], s59 offen offset:1024 nt lds
    buffer_load_dwordx4 v4, s[28:31], s59 offen offset:2048 nt lds
    buffer_load_dwordx4 v5, s[28:31], s59 offen offset:3072 nt lds
    s_mov_b32 m0, 45056
    s_mov_b32 s59, 77824
    buffer_load_dwordx4 v2, s[28:31], s59 offen offset:0 nt lds
    buffer_load_dwordx4 v3, s[28:31], s59 offen offset:1024 nt lds
    buffer_load_dwordx4 v4, s[28:31], s59 offen offset:2048 nt lds
    buffer_load_dwordx4 v5, s[28:31], s59 offen offset:3072 nt lds
    s_mov_b32 m0, 49152
    s_mov_b32 s59, 49152
    buffer_load_dwordx4 v6, s[32:35], s59 offen offset:0 nt lds
    buffer_load_dwordx4 v6, s[32:35], s59 offen offset:1024 nt lds
    buffer_load_dwordx4 v6, s[32:35], s59 offen offset:2048 nt lds
    buffer_load_dwordx4 v6, s[32:35], s59 offen offset:3072 nt lds
    s_mov_b32 m0, 53248
    s_mov_b32 s59, 53248
    buffer_load_dwordx4 v6, s[32:35], s59 offen offset:0 nt lds
    buffer_load_dwordx4 v6, s[32:35], s59 offen offset:1024 nt lds
    buffer_load_dwordx4 v6, s[32:35], s59 offen offset:2048 nt lds
    buffer_load_dwordx4 v6, s[32:35], s59 offen offset:3072 nt lds
    s_mov_b32 m0, 57344
    s_mov_b32 s59, 57344
    buffer_load_dwordx4 v6, s[32:35], s59 offen offset:0 nt lds
    buffer_load_dwordx4 v6, s[32:35], s59 offen offset:1024 nt lds
    buffer_load_dwordx4 v6, s[32:35], s59 offen offset:2048 nt lds
    buffer_load_dwordx4 v6, s[32:35], s59 offen offset:3072 nt lds
    s_mov_b32 m0, 61440
    s_mov_b32 s59, 61440
    buffer_load_dwordx4 v6, s[32:35], s59 offen offset:0 nt lds
    buffer_load_dwordx4 v6, s[32:35], s59 offen offset:1024 nt lds
    buffer_load_dwordx4 v6, s[32:35], s59 offen offset:2048 nt lds
    buffer_load_dwordx4 v6, s[32:35], s59 offen offset:3072 nt lds
    s_waitcnt vmcnt(48)
    s_barrier
    s_mov_b32 m0, 65536
    s_mov_b32 s59, 81920
    buffer_load_dwordx4 v2, s[28:31], s59 offen offset:0 nt lds
    buffer_load_dwordx4 v3, s[28:31], s59 offen offset:1024 nt lds
    buffer_load_dwordx4 v4, s[28:31], s59 offen offset:2048 nt lds
    buffer_load_dwordx4 v5, s[28:31], s59 offen offset:3072 nt lds
    s_mov_b32 m0, 69632
    s_mov_b32 s59, 86016
    buffer_load_dwordx4 v2, s[28:31], s59 offen offset:0 nt lds
    buffer_load_dwordx4 v3, s[28:31], s59 offen offset:1024 nt lds
    buffer_load_dwordx4 v4, s[28:31], s59 offen offset:2048 nt lds
    buffer_load_dwordx4 v5, s[28:31], s59 offen offset:3072 nt lds
    s_mov_b32 m0, 73728
    s_mov_b32 s59, 90112
    buffer_load_dwordx4 v2, s[28:31], s59 offen offset:0 nt lds
    buffer_load_dwordx4 v3, s[28:31], s59 offen offset:1024 nt lds
    buffer_load_dwordx4 v4, s[28:31], s59 offen offset:2048 nt lds
    buffer_load_dwordx4 v5, s[28:31], s59 offen offset:3072 nt lds
    s_mov_b32 m0, 77824
    s_mov_b32 s59, 94208
    buffer_load_dwordx4 v2, s[28:31], s59 offen offset:0 nt lds
    buffer_load_dwordx4 v3, s[28:31], s59 offen offset:1024 nt lds
    buffer_load_dwordx4 v4, s[28:31], s59 offen offset:2048 nt lds
    buffer_load_dwordx4 v5, s[28:31], s59 offen offset:3072 nt lds
    s_mov_b32 m0, 81920
    s_mov_b32 s59, 65536
    buffer_load_dwordx4 v6, s[32:35], s59 offen offset:0 nt lds
    buffer_load_dwordx4 v6, s[32:35], s59 offen offset:1024 nt lds
    buffer_load_dwordx4 v6, s[32:35], s59 offen offset:2048 nt lds
    buffer_load_dwordx4 v6, s[32:35], s59 offen offset:3072 nt lds
    s_mov_b32 m0, 86016
    s_mov_b32 s59, 69632
    buffer_load_dwordx4 v6, s[32:35], s59 offen offset:0 nt lds
    buffer_load_dwordx4 v6, s[32:35], s59 offen offset:1024 nt lds
    buffer_load_dwordx4 v6, s[32:35], s59 offen offset:2048 nt lds
    buffer_load_dwordx4 v6, s[32:35], s59 offen offset:3072 nt lds
    s_mov_b32 m0, 90112
    s_mov_b32 s59, 73728
    buffer_load_dwordx4 v6, s[32:35], s59 offen offset:0 nt lds
    buffer_load_dwordx4 v6, s[32:35], s59 offen offset:1024 nt lds
    buffer_load_dwordx4 v6, s[32:35], s59 offen offset:2048 nt lds
    buffer_load_dwordx4 v6, s[32:35], s59 offen offset:3072 nt lds
    s_mov_b32 m0, 94208
    s_mov_b32 s59, 77824
    buffer_load_dwordx4 v6, s[32:35], s59 offen offset:0 nt lds
    buffer_load_dwordx4 v6, s[32:35], s59 offen offset:1024 nt lds
    buffer_load_dwordx4 v6, s[32:35], s59 offen offset:2048 nt lds
    buffer_load_dwordx4 v6, s[32:35], s59 offen offset:3072 nt lds
    s_waitcnt vmcnt(48)
    s_barrier
    s_mov_b32 m0, 98304
    s_mov_b32 s59, 98304
    buffer_load_dwordx4 v2, s[28:31], s59 offen offset:0 nt lds
    buffer_load_dwordx4 v3, s[28:31], s59 offen offset:1024 nt lds
    buffer_load_dwordx4 v4, s[28:31], s59 offen offset:2048 nt lds
    buffer_load_dwordx4 v5, s[28:31], s59 offen offset:3072 nt lds
    s_mov_b32 m0, 102400
    s_mov_b32 s59, 102400
    buffer_load_dwordx4 v2, s[28:31], s59 offen offset:0 nt lds
    buffer_load_dwordx4 v3, s[28:31], s59 offen offset:1024 nt lds
    buffer_load_dwordx4 v4, s[28:31], s59 offen offset:2048 nt lds
    buffer_load_dwordx4 v5, s[28:31], s59 offen offset:3072 nt lds
    s_mov_b32 m0, 106496
    s_mov_b32 s59, 106496
    buffer_load_dwordx4 v2, s[28:31], s59 offen offset:0 nt lds
    buffer_load_dwordx4 v3, s[28:31], s59 offen offset:1024 nt lds
    buffer_load_dwordx4 v4, s[28:31], s59 offen offset:2048 nt lds
    buffer_load_dwordx4 v5, s[28:31], s59 offen offset:3072 nt lds
    s_mov_b32 m0, 110592
    s_mov_b32 s59, 110592
    buffer_load_dwordx4 v2, s[28:31], s59 offen offset:0 nt lds
    buffer_load_dwordx4 v3, s[28:31], s59 offen offset:1024 nt lds
    buffer_load_dwordx4 v4, s[28:31], s59 offen offset:2048 nt lds
    buffer_load_dwordx4 v5, s[28:31], s59 offen offset:3072 nt lds
    s_mov_b32 m0, 114688
    s_mov_b32 s59, 81920
    buffer_load_dwordx4 v6, s[32:35], s59 offen offset:0 nt lds
    buffer_load_dwordx4 v6, s[32:35], s59 offen offset:1024 nt lds
    buffer_load_dwordx4 v6, s[32:35], s59 offen offset:2048 nt lds
    buffer_load_dwordx4 v6, s[32:35], s59 offen offset:3072 nt lds
    s_mov_b32 m0, 118784
    s_mov_b32 s59, 86016
    buffer_load_dwordx4 v6, s[32:35], s59 offen offset:0 nt lds
    buffer_load_dwordx4 v6, s[32:35], s59 offen offset:1024 nt lds
    buffer_load_dwordx4 v6, s[32:35], s59 offen offset:2048 nt lds
    buffer_load_dwordx4 v6, s[32:35], s59 offen offset:3072 nt lds
    s_mov_b32 m0, 122880
    s_mov_b32 s59, 90112
    buffer_load_dwordx4 v6, s[32:35], s59 offen offset:0 nt lds
    buffer_load_dwordx4 v6, s[32:35], s59 offen offset:1024 nt lds
    buffer_load_dwordx4 v6, s[32:35], s59 offen offset:2048 nt lds
    buffer_load_dwordx4 v6, s[32:35], s59 offen offset:3072 nt lds
    s_mov_b32 m0, 126976
    s_mov_b32 s59, 94208
    buffer_load_dwordx4 v6, s[32:35], s59 offen offset:0 nt lds
    buffer_load_dwordx4 v6, s[32:35], s59 offen offset:1024 nt lds
    buffer_load_dwordx4 v6, s[32:35], s59 offen offset:2048 nt lds
    buffer_load_dwordx4 v6, s[32:35], s59 offen offset:3072 nt lds
    s_waitcnt vmcnt(48)
    s_barrier
    s_mov_b32 m0, 131072
    s_mov_b32 s59, 114688
    buffer_load_dwordx4 v2, s[28:31], s59 offen offset:0 nt lds
    buffer_load_dwordx4 v3, s[28:31], s59 offen offset:1024 nt lds
    buffer_load_dwordx4 v4, s[28:31], s59 offen offset:2048 nt lds
    buffer_load_dwordx4 v5, s[28:31], s59 offen offset:3072 nt lds
    s_mov_b32 m0, 135168
    s_mov_b32 s59, 118784
    buffer_load_dwordx4 v2, s[28:31], s59 offen offset:0 nt lds
    buffer_load_dwordx4 v3, s[28:31], s59 offen offset:1024 nt lds
    buffer_load_dwordx4 v4, s[28:31], s59 offen offset:2048 nt lds
    buffer_load_dwordx4 v5, s[28:31], s59 offen offset:3072 nt lds
    s_mov_b32 m0, 139264
    s_mov_b32 s59, 122880
    buffer_load_dwordx4 v2, s[28:31], s59 offen offset:0 nt lds
    buffer_load_dwordx4 v3, s[28:31], s59 offen offset:1024 nt lds
    buffer_load_dwordx4 v4, s[28:31], s59 offen offset:2048 nt lds
    buffer_load_dwordx4 v5, s[28:31], s59 offen offset:3072 nt lds
    s_mov_b32 m0, 143360
    s_mov_b32 s59, 126976
    buffer_load_dwordx4 v2, s[28:31], s59 offen offset:0 nt lds
    buffer_load_dwordx4 v3, s[28:31], s59 offen offset:1024 nt lds
    buffer_load_dwordx4 v4, s[28:31], s59 offen offset:2048 nt lds
    buffer_load_dwordx4 v5, s[28:31], s59 offen offset:3072 nt lds
    s_mov_b32 m0, 147456
    s_mov_b32 s59, 98304
    buffer_load_dwordx4 v6, s[32:35], s59 offen offset:0 nt lds
    buffer_load_dwordx4 v6, s[32:35], s59 offen offset:1024 nt lds
    buffer_load_dwordx4 v6, s[32:35], s59 offen offset:2048 nt lds
    buffer_load_dwordx4 v6, s[32:35], s59 offen offset:3072 nt lds
    s_mov_b32 m0, 151552
    s_mov_b32 s59, 102400
    buffer_load_dwordx4 v6, s[32:35], s59 offen offset:0 nt lds
    buffer_load_dwordx4 v6, s[32:35], s59 offen offset:1024 nt lds
    buffer_load_dwordx4 v6, s[32:35], s59 offen offset:2048 nt lds
    buffer_load_dwordx4 v6, s[32:35], s59 offen offset:3072 nt lds
    s_mov_b32 m0, 155648
    s_mov_b32 s59, 106496
    buffer_load_dwordx4 v6, s[32:35], s59 offen offset:0 nt lds
    buffer_load_dwordx4 v6, s[32:35], s59 offen offset:1024 nt lds
    buffer_load_dwordx4 v6, s[32:35], s59 offen offset:2048 nt lds
    buffer_load_dwordx4 v6, s[32:35], s59 offen offset:3072 nt lds
    s_mov_b32 m0, 159744
    s_mov_b32 s59, 110592
    buffer_load_dwordx4 v6, s[32:35], s59 offen offset:0 nt lds
    buffer_load_dwordx4 v6, s[32:35], s59 offen offset:1024 nt lds
    buffer_load_dwordx4 v6, s[32:35], s59 offen offset:2048 nt lds
    buffer_load_dwordx4 v6, s[32:35], s59 offen offset:3072 nt lds
    s_waitcnt vmcnt(48)
    s_barrier
    s_mov_b32 m0, 0
    s_mov_b32 s59, 131072
    buffer_load_dwordx4 v2, s[28:31], s59 offen offset:0 nt lds
    buffer_load_dwordx4 v3, s[28:31], s59 offen offset:1024 nt lds
    buffer_load_dwordx4 v4, s[28:31], s59 offen offset:2048 nt lds
    buffer_load_dwordx4 v5, s[28:31], s59 offen offset:3072 nt lds
    s_mov_b32 m0, 4096
    s_mov_b32 s59, 135168
    buffer_load_dwordx4 v2, s[28:31], s59 offen offset:0 nt lds
    buffer_load_dwordx4 v3, s[28:31], s59 offen offset:1024 nt lds
    buffer_load_dwordx4 v4, s[28:31], s59 offen offset:2048 nt lds
    buffer_load_dwordx4 v5, s[28:31], s59 offen offset:3072 nt lds
    s_mov_b32 m0, 8192
    s_mov_b32 s59, 139264
    buffer_load_dwordx4 v2, s[28:31], s59 offen offset:0 nt lds
    buffer_load_dwordx4 v3, s[28:31], s59 offen offset:1024 nt lds
    buffer_load_dwordx4 v4, s[28:31], s59 offen offset:2048 nt lds
    buffer_load_dwordx4 v5, s[28:31], s59 offen offset:3072 nt lds
    s_mov_b32 m0, 12288
    s_mov_b32 s59, 143360
    buffer_load_dwordx4 v2, s[28:31], s59 offen offset:0 nt lds
    buffer_load_dwordx4 v3, s[28:31], s59 offen offset:1024 nt lds
    buffer_load_dwordx4 v4, s[28:31], s59 offen offset:2048 nt lds
    buffer_load_dwordx4 v5, s[28:31], s59 offen offset:3072 nt lds
    s_mov_b32 m0, 16384
    s_mov_b32 s59, 114688
    buffer_load_dwordx4 v6, s[32:35], s59 offen offset:0 nt lds
    buffer_load_dwordx4 v6, s[32:35], s59 offen offset:1024 nt lds
    buffer_load_dwordx4 v6, s[32:35], s59 offen offset:2048 nt lds
    buffer_load_dwordx4 v6, s[32:35], s59 offen offset:3072 nt lds
    s_mov_b32 m0, 20480
    s_mov_b32 s59, 118784
    buffer_load_dwordx4 v6, s[32:35], s59 offen offset:0 nt lds
    buffer_load_dwordx4 v6, s[32:35], s59 offen offset:1024 nt lds
    buffer_load_dwordx4 v6, s[32:35], s59 offen offset:2048 nt lds
    buffer_load_dwordx4 v6, s[32:35], s59 offen offset:3072 nt lds
    s_mov_b32 m0, 24576
    s_mov_b32 s59, 122880
    buffer_load_dwordx4 v6, s[32:35], s59 offen offset:0 nt lds
    buffer_load_dwordx4 v6, s[32:35], s59 offen offset:1024 nt lds
    buffer_load_dwordx4 v6, s[32:35], s59 offen offset:2048 nt lds
    buffer_load_dwordx4 v6, s[32:35], s59 offen offset:3072 nt lds
    s_mov_b32 m0, 28672
    s_mov_b32 s59, 126976
    buffer_load_dwordx4 v6, s[32:35], s59 offen offset:0 nt lds
    buffer_load_dwordx4 v6, s[32:35], s59 offen offset:1024 nt lds
    buffer_load_dwordx4 v6, s[32:35], s59 offen offset:2048 nt lds
    buffer_load_dwordx4 v6, s[32:35], s59 offen offset:3072 nt lds
    s_waitcnt vmcnt(48)
    s_barrier
    s_mov_b32 m0, 32768
    s_mov_b32 s59, 147456
    buffer_load_dwordx4 v2, s[28:31], s59 offen offset:0 nt lds
    buffer_load_dwordx4 v3, s[28:31], s59 offen offset:1024 nt lds
    buffer_load_dwordx4 v4, s[28:31], s59 offen offset:2048 nt lds
    buffer_load_dwordx4 v5, s[28:31], s59 offen offset:3072 nt lds
    s_mov_b32 m0, 36864
    s_mov_b32 s59, 151552
    buffer_load_dwordx4 v2, s[28:31], s59 offen offset:0 nt lds
    buffer_load_dwordx4 v3, s[28:31], s59 offen offset:1024 nt lds
    buffer_load_dwordx4 v4, s[28:31], s59 offen offset:2048 nt lds
    buffer_load_dwordx4 v5, s[28:31], s59 offen offset:3072 nt lds
    s_mov_b32 m0, 40960
    s_mov_b32 s59, 155648
    buffer_load_dwordx4 v2, s[28:31], s59 offen offset:0 nt lds
    buffer_load_dwordx4 v3, s[28:31], s59 offen offset:1024 nt lds
    buffer_load_dwordx4 v4, s[28:31], s59 offen offset:2048 nt lds
    buffer_load_dwordx4 v5, s[28:31], s59 offen offset:3072 nt lds
    s_mov_b32 m0, 45056
    s_mov_b32 s59, 159744
    buffer_load_dwordx4 v2, s[28:31], s59 offen offset:0 nt lds
    buffer_load_dwordx4 v3, s[28:31], s59 offen offset:1024 nt lds
    buffer_load_dwordx4 v4, s[28:31], s59 offen offset:2048 nt lds
    buffer_load_dwordx4 v5, s[28:31], s59 offen offset:3072 nt lds
    s_mov_b32 m0, 49152
    s_mov_b32 s59, 131072
    buffer_load_dwordx4 v6, s[32:35], s59 offen offset:0 nt lds
    buffer_load_dwordx4 v6, s[32:35], s59 offen offset:1024 nt lds
    buffer_load_dwordx4 v6, s[32:35], s59 offen offset:2048 nt lds
    buffer_load_dwordx4 v6, s[32:35], s59 offen offset:3072 nt lds
    s_mov_b32 m0, 53248
    s_mov_b32 s59, 135168
    buffer_load_dwordx4 v6, s[32:35], s59 offen offset:0 nt lds
    buffer_load_dwordx4 v6, s[32:35], s59 offen offset:1024 nt lds
    buffer_load_dwordx4 v6, s[32:35], s59 offen offset:2048 nt lds
    buffer_load_dwordx4 v6, s[32:35], s59 offen offset:3072 nt lds
    s_mov_b32 m0, 57344
    s_mov_b32 s59, 139264
    buffer_load_dwordx4 v6, s[32:35], s59 offen offset:0 nt lds
    buffer_load_dwordx4 v6, s[32:35], s59 offen offset:1024 nt lds
    buffer_load_dwordx4 v6, s[32:35], s59 offen offset:2048 nt lds
    buffer_load_dwordx4 v6, s[32:35], s59 offen offset:3072 nt lds
    s_mov_b32 m0, 61440
    s_mov_b32 s59, 143360
    buffer_load_dwordx4 v6, s[32:35], s59 offen offset:0 nt lds
    buffer_load_dwordx4 v6, s[32:35], s59 offen offset:1024 nt lds
    buffer_load_dwordx4 v6, s[32:35], s59 offen offset:2048 nt lds
    buffer_load_dwordx4 v6, s[32:35], s59 offen offset:3072 nt lds
    buffer_load_dword v32, v28, s[48:51], 0 offen sc1
    s_waitcnt vmcnt(49)
    s_barrier
    s_mov_b32 m0, 65536
    s_mov_b32 s59, 163840
    buffer_load_dwordx4 v2, s[28:31], s59 offen offset:0 nt lds
    buffer_load_dwordx4 v3, s[28:31], s59 offen offset:1024 nt lds
    buffer_load_dwordx4 v4, s[28:31], s59 offen offset:2048 nt lds
    buffer_load_dwordx4 v5, s[28:31], s59 offen offset:3072 nt lds
    s_mov_b32 m0, 69632
    s_mov_b32 s59, 167936
    buffer_load_dwordx4 v2, s[28:31], s59 offen offset:0 nt lds
    buffer_load_dwordx4 v3, s[28:31], s59 offen offset:1024 nt lds
    buffer_load_dwordx4 v4, s[28:31], s59 offen offset:2048 nt lds
    buffer_load_dwordx4 v5, s[28:31], s59 offen offset:3072 nt lds
    s_mov_b32 m0, 73728
    s_mov_b32 s59, 172032
    buffer_load_dwordx4 v2, s[28:31], s59 offen offset:0 nt lds
    buffer_load_dwordx4 v3, s[28:31], s59 offen offset:1024 nt lds
    buffer_load_dwordx4 v4, s[28:31], s59 offen offset:2048 nt lds
    buffer_load_dwordx4 v5, s[28:31], s59 offen offset:3072 nt lds
    s_mov_b32 m0, 77824
    s_mov_b32 s59, 176128
    buffer_load_dwordx4 v2, s[28:31], s59 offen offset:0 nt lds
    buffer_load_dwordx4 v3, s[28:31], s59 offen offset:1024 nt lds
    buffer_load_dwordx4 v4, s[28:31], s59 offen offset:2048 nt lds
    buffer_load_dwordx4 v5, s[28:31], s59 offen offset:3072 nt lds
    s_mov_b32 m0, 81920
    s_mov_b32 s59, 147456
    buffer_load_dwordx4 v6, s[32:35], s59 offen offset:0 nt lds
    buffer_load_dwordx4 v6, s[32:35], s59 offen offset:1024 nt lds
    buffer_load_dwordx4 v6, s[32:35], s59 offen offset:2048 nt lds
    buffer_load_dwordx4 v6, s[32:35], s59 offen offset:3072 nt lds
    s_mov_b32 m0, 86016
    s_mov_b32 s59, 151552
    buffer_load_dwordx4 v6, s[32:35], s59 offen offset:0 nt lds
    buffer_load_dwordx4 v6, s[32:35], s59 offen offset:1024 nt lds
    buffer_load_dwordx4 v6, s[32:35], s59 offen offset:2048 nt lds
    buffer_load_dwordx4 v6, s[32:35], s59 offen offset:3072 nt lds
    s_mov_b32 m0, 90112
    s_mov_b32 s59, 155648
    buffer_load_dwordx4 v6, s[32:35], s59 offen offset:0 nt lds
    buffer_load_dwordx4 v6, s[32:35], s59 offen offset:1024 nt lds
    buffer_load_dwordx4 v6, s[32:35], s59 offen offset:2048 nt lds
    buffer_load_dwordx4 v6, s[32:35], s59 offen offset:3072 nt lds
    s_mov_b32 m0, 94208
    s_mov_b32 s59, 159744
    buffer_load_dwordx4 v6, s[32:35], s59 offen offset:0 nt lds
    buffer_load_dwordx4 v6, s[32:35], s59 offen offset:1024 nt lds
    buffer_load_dwordx4 v6, s[32:35], s59 offen offset:2048 nt lds
    buffer_load_dwordx4 v6, s[32:35], s59 offen offset:3072 nt lds
    s_waitcnt vmcnt(49)
    s_barrier
    s_mov_b32 m0, 98304
    s_mov_b32 s59, 180224
    buffer_load_dwordx4 v2, s[28:31], s59 offen offset:0 nt lds
    buffer_load_dwordx4 v3, s[28:31], s59 offen offset:1024 nt lds
    buffer_load_dwordx4 v4, s[28:31], s59 offen offset:2048 nt lds
    buffer_load_dwordx4 v5, s[28:31], s59 offen offset:3072 nt lds
    s_mov_b32 m0, 102400
    s_mov_b32 s59, 184320
    buffer_load_dwordx4 v2, s[28:31], s59 offen offset:0 nt lds
    buffer_load_dwordx4 v3, s[28:31], s59 offen offset:1024 nt lds
    buffer_load_dwordx4 v4, s[28:31], s59 offen offset:2048 nt lds
    buffer_load_dwordx4 v5, s[28:31], s59 offen offset:3072 nt lds
    s_mov_b32 m0, 106496
    s_mov_b32 s59, 188416
    buffer_load_dwordx4 v2, s[28:31], s59 offen offset:0 nt lds
    buffer_load_dwordx4 v3, s[28:31], s59 offen offset:1024 nt lds
    buffer_load_dwordx4 v4, s[28:31], s59 offen offset:2048 nt lds
    buffer_load_dwordx4 v5, s[28:31], s59 offen offset:3072 nt lds
    s_mov_b32 m0, 110592
    s_mov_b32 s59, 192512
    buffer_load_dwordx4 v2, s[28:31], s59 offen offset:0 nt lds
    buffer_load_dwordx4 v3, s[28:31], s59 offen offset:1024 nt lds
    buffer_load_dwordx4 v4, s[28:31], s59 offen offset:2048 nt lds
    buffer_load_dwordx4 v5, s[28:31], s59 offen offset:3072 nt lds
    s_mov_b32 m0, 114688
    s_mov_b32 s59, 163840
    buffer_load_dwordx4 v6, s[32:35], s59 offen offset:0 nt lds
    buffer_load_dwordx4 v6, s[32:35], s59 offen offset:1024 nt lds
    buffer_load_dwordx4 v6, s[32:35], s59 offen offset:2048 nt lds
    buffer_load_dwordx4 v6, s[32:35], s59 offen offset:3072 nt lds
    s_mov_b32 m0, 118784
    s_mov_b32 s59, 167936
    buffer_load_dwordx4 v6, s[32:35], s59 offen offset:0 nt lds
    buffer_load_dwordx4 v6, s[32:35], s59 offen offset:1024 nt lds
    buffer_load_dwordx4 v6, s[32:35], s59 offen offset:2048 nt lds
    buffer_load_dwordx4 v6, s[32:35], s59 offen offset:3072 nt lds
    s_mov_b32 m0, 122880
    s_mov_b32 s59, 172032
    buffer_load_dwordx4 v6, s[32:35], s59 offen offset:0 nt lds
    buffer_load_dwordx4 v6, s[32:35], s59 offen offset:1024 nt lds
    buffer_load_dwordx4 v6, s[32:35], s59 offen offset:2048 nt lds
    buffer_load_dwordx4 v6, s[32:35], s59 offen offset:3072 nt lds
    s_mov_b32 m0, 126976
    s_mov_b32 s59, 176128
    buffer_load_dwordx4 v6, s[32:35], s59 offen offset:0 nt lds
    buffer_load_dwordx4 v6, s[32:35], s59 offen offset:1024 nt lds
    buffer_load_dwordx4 v6, s[32:35], s59 offen offset:2048 nt lds
    buffer_load_dwordx4 v6, s[32:35], s59 offen offset:3072 nt lds
    s_waitcnt vmcnt(63)
    v_readfirstlane_b32 s71, v32
    s_nop 3
    s_cmp_eq_u32 s71, 0
    s_cbranch_scc1 L_tag_l1
    v_mov_b32 v21, s65
    s_mov_b64 exec, 1
    buffer_store_dword v21, v24, s[40:43], 0 offen sc1
    s_mov_b64 exec, -1
L_tag_l1:
    s_waitcnt vmcnt(48)
    s_barrier
    s_mov_b32 m0, 131072
    s_mov_b32 s59, 196608
    buffer_load_dwordx4 v2, s[28:31], s59 offen offset:0 nt lds
    buffer_load_dwordx4 v3, s[28:31], s59 offen offset:1024 nt lds
    buffer_load_dwordx4 v4, s[28:31], s59 offen offset:2048 nt lds
    buffer_load_dwordx4 v5, s[28:31], s59 offen offset:3072 nt lds
    s_mov_b32 m0, 135168
    s_mov_b32 s59, 200704
    buffer_load_dwordx4 v2, s[28:31], s59 offen offset:0 nt lds
    buffer_load_dwordx4 v3, s[28:31], s59 offen offset:1024 nt lds
    buffer_load_dwordx4 v4, s[28:31], s59 offen offset:2048 nt lds
    buffer_load_dwordx4 v5, s[28:31], s59 offen offset:3072 nt lds
    s_mov_b32 m0, 139264
    s_mov_b32 s59, 204800
    buffer_load_dwordx4 v2, s[28:31], s59 offen offset:0 nt lds
    buffer_load_dwordx4 v3, s[28:31], s59 offen offset:1024 nt lds
    buffer_load_dwordx4 v4, s[28:31], s59 offen offset:2048 nt lds
    buffer_load_dwordx4 v5, s[28:31], s59 offen offset:3072 nt lds
    s_mov_b32 m0, 143360
    s_mov_b32 s59, 208896
    buffer_load_dwordx4 v2, s[28:31], s59 offen offset:0 nt lds
    buffer_load_dwordx4 v3, s[28:31], s59 offen offset:1024 nt lds
    buffer_load_dwordx4 v4, s[28:31], s59 offen offset:2048 nt lds
    buffer_load_dwordx4 v5, s[28:31], s59 offen offset:3072 nt lds
    s_mov_b32 m0, 147456
    s_mov_b32 s59, 180224
    buffer_load_dwordx4 v6, s[32:35], s59 offen offset:0 nt lds
    buffer_load_dwordx4 v6, s[32:35], s59 offen offset:1024 nt lds
    buffer_load_dwordx4 v6, s[32:35], s59 offen offset:2048 nt lds
    buffer_load_dwordx4 v6, s[32:35], s59 offen offset:3072 nt lds
    s_mov_b32 m0, 151552
    s_mov_b32 s59, 184320
    buffer_load_dwordx4 v6, s[32:35], s59 offen offset:0 nt lds
    buffer_load_dwordx4 v6, s[32:35], s59 offen offset:1024 nt lds
    buffer_load_dwordx4 v6, s[32:35], s59 offen offset:2048 nt lds
    buffer_load_dwordx4 v6, s[32:35], s59 offen offset:3072 nt lds
    s_mov_b32 m0, 155648
    s_mov_b32 s59, 188416
    buffer_load_dwordx4 v6, s[32:35], s59 offen offset:0 nt lds
    buffer_load_dwordx4 v6, s[32:35], s59 offen offset:1024 nt lds
    buffer_load_dwordx4 v6, s[32:35], s59 offen offset:2048 nt lds
    buffer_load_dwordx4 v6, s[32:35], s59 offen offset:3072 nt lds
    s_mov_b32 m0, 159744
    s_mov_b32 s59, 192512
    buffer_load_dwordx4 v6, s[32:35], s59 offen offset:0 nt lds
    buffer_load_dwordx4 v6, s[32:35], s59 offen offset:1024 nt lds
    buffer_load_dwordx4 v6, s[32:35], s59 offen offset:2048 nt lds
    buffer_load_dwordx4 v6, s[32:35], s59 offen offset:3072 nt lds
    s_waitcnt vmcnt(48)
    s_barrier
    s_mov_b32 m0, 0
    s_mov_b32 s59, 212992
    buffer_load_dwordx4 v2, s[28:31], s59 offen offset:0 nt lds
    buffer_load_dwordx4 v3, s[28:31], s59 offen offset:1024 nt lds
    buffer_load_dwordx4 v4, s[28:31], s59 offen offset:2048 nt lds
    buffer_load_dwordx4 v5, s[28:31], s59 offen offset:3072 nt lds
    s_mov_b32 m0, 4096
    s_mov_b32 s59, 217088
    buffer_load_dwordx4 v2, s[28:31], s59 offen offset:0 nt lds
    buffer_load_dwordx4 v3, s[28:31], s59 offen offset:1024 nt lds
    buffer_load_dwordx4 v4, s[28:31], s59 offen offset:2048 nt lds
    buffer_load_dwordx4 v5, s[28:31], s59 offen offset:3072 nt lds
    s_mov_b32 m0, 8192
    s_mov_b32 s59, 221184
    buffer_load_dwordx4 v2, s[28:31], s59 offen offset:0 nt lds
    buffer_load_dwordx4 v3, s[28:31], s59 offen offset:1024 nt lds
    buffer_load_dwordx4 v4, s[28:31], s59 offen offset:2048 nt lds
    buffer_load_dwordx4 v5, s[28:31], s59 offen offset:3072 nt lds
    s_mov_b32 m0, 12288
    s_mov_b32 s59, 225280
    buffer_load_dwordx4 v2, s[28:31], s59 offen offset:0 nt lds
    buffer_load_dwordx4 v3, s[28:31], s59 offen offset:1024 nt lds
    buffer_load_dwordx4 v4, s[28:31], s59 offen offset:2048 nt lds
    buffer_load_dwordx4 v5, s[28:31], s59 offen offset:3072 nt lds
    s_mov_b32 m0, 16384
    s_mov_b32 s59, 196608
    buffer_load_dwordx4 v6, s[32:35], s59 offen offset:0 nt lds
    buffer_load_dwordx4 v6, s[32:35], s59 offen offset:1024 nt lds
    buffer_load_dwordx4 v6, s[32:35], s59 offen offset:2048 nt lds
    buffer_load_dwordx4 v6, s[32:35], s59 offen offset:3072 nt lds
    s_mov_b32 m0, 20480
    s_mov_b32 s59, 200704
    buffer_load_dwordx4 v6, s[32:35], s59 offen offset:0 nt lds
    buffer_load_dwordx4 v6, s[32:35], s59 offen offset:1024 nt lds
    buffer_load_dwordx4 v6, s[32:35], s59 offen offset:2048 nt lds
    buffer_load_dwordx4 v6, s[32:35], s59 offen offset:3072 nt lds
    s_mov_b32 m0, 24576
    s_mov_b32 s59, 204800
    buffer_load_dwordx4 v6, s[32:35], s59 offen offset:0 nt lds
    buffer_load_dwordx4 v6, s[32:35], s59 offen offset:1024 nt lds
    buffer_load_dwordx4 v6, s[32:35], s59 offen offset:2048 nt lds
    buffer_load_dwordx4 v6, s[32:35], s59 offen offset:3072 nt lds
    s_mov_b32 m0, 28672
    s_mov_b32 s59, 208896
    buffer_load_dwordx4 v6, s[32:35], s59 offen offset:0 nt lds
    buffer_load_dwordx4 v6, s[32:35], s59 offen offset:1024 nt lds
    buffer_load_dwordx4 v6, s[32:35], s59 offen offset:2048 nt lds
    buffer_load_dwordx4 v6, s[32:35], s59 offen offset:3072 nt lds
    s_waitcnt vmcnt(48)
    s_barrier
    s_mov_b32 m0, 32768
    s_mov_b32 s59, 229376
    buffer_load_dwordx4 v2, s[28:31], s59 offen offset:0 nt lds
    buffer_load_dwordx4 v3, s[28:31], s59 offen offset:1024 nt lds
    buffer_load_dwordx4 v4, s[28:31], s59 offen offset:2048 nt lds
    buffer_load_dwordx4 v5, s[28:31], s59 offen offset:3072 nt lds
    s_mov_b32 m0, 36864
    s_mov_b32 s59, 233472
    buffer_load_dwordx4 v2, s[28:31], s59 offen offset:0 nt lds
    buffer_load_dwordx4 v3, s[28:31], s59 offen offset:1024 nt lds
    buffer_load_dwordx4 v4, s[28:31], s59 offen offset:2048 nt lds
    buffer_load_dwordx4 v5, s[28:31], s59 offen offset:3072 nt lds
    s_mov_b32 m0, 40960
    s_mov_b32 s59, 237568
    buffer_load_dwordx4 v2, s[28:31], s59 offen offset:0 nt lds
    buffer_load_dwordx4 v3, s[28:31], s59 offen offset:1024 nt lds
    buffer_load_dwordx4 v4, s[28:31], s59 offen offset:2048 nt lds
    buffer_load_dwordx4 v5, s[28:31], s59 offen offset:3072 nt lds
    s_mov_b32 m0, 45056
    s_mov_b32 s59, 241664
    buffer_load_dwordx4 v2, s[28:31], s59 offen offset:0 nt lds
    buffer_load_dwordx4 v3, s[28:31], s59 offen offset:1024 nt lds
    buffer_load_dwordx4 v4, s[28:31], s59 offen offset:2048 nt lds
    buffer_load_dwordx4 v5, s[28:31], s59 offen offset:3072 nt lds
    s_mov_b32 m0, 49152
    s_mov_b32 s59, 212992
    buffer_load_dwordx4 v6, s[32:35], s59 offen offset:0 nt lds
    buffer_load_dwordx4 v6, s[32:35], s59 offen offset:1024 nt lds
    buffer_load_dwordx4 v6, s[32:35], s59 offen offset:2048 nt lds
    buffer_load_dwordx4 v6, s[32:35], s59 offen offset:3072 nt lds
    s_mov_b32 m0, 53248
    s_mov_b32 s59, 217088
    buffer_load_dwordx4 v6, s[32:35], s59 offen offset:0 nt lds
    buffer_load_dwordx4 v6, s[32:35], s59 offen offset:1024 nt lds
    buffer_load_dwordx4 v6, s[32:35], s59 offen offset:2048 nt lds
    buffer_load_dwordx4 v6, s[32:35], s59 offen offset:3072 nt lds
    s_mov_b32 m0, 57344
    s_mov_b32 s59, 221184
    buffer_load_dwordx4 v6, s[32:35], s59 offen offset:0 nt lds
    buffer_load_dwordx4 v6, s[32:35], s59 offen offset:1024 nt lds
    buffer_load_dwordx4 v6, s[32:35], s59 offen offset:2048 nt lds
    buffer_load_dwordx4 v6, s[32:35], s59 offen offset:3072 nt lds
    s_mov_b32 m0, 61440
    s_mov_b32 s59, 225280
    buffer_load_dwordx4 v6, s[32:35], s59 offen offset:0 nt lds
    buffer_load_dwordx4 v6, s[32:35], s59 offen offset:1024 nt lds
    buffer_load_dwordx4 v6, s[32:35], s59 offen offset:2048 nt lds
    buffer_load_dwordx4 v6, s[32:35], s59 offen offset:3072 nt lds
    buffer_load_dword v33, v26, s[40:43], 0 offen sc1
    s_waitcnt vmcnt(49)
    s_barrier
    s_mov_b32 m0, 65536
    s_mov_b32 s59, 245760
    buffer_load_dwordx4 v2, s[28:31], s59 offen offset:0 nt lds
    buffer_load_dwordx4 v3, s[28:31], s59 offen offset:1024 nt lds
    buffer_load_dwordx4 v4, s[28:31], s59 offen offset:2048 nt lds
    buffer_load_dwordx4 v5, s[28:31], s59 offen offset:3072 nt lds
    s_mov_b32 m0, 69632
    s_mov_b32 s59, 249856
    buffer_load_dwordx4 v2, s[28:31], s59 offen offset:0 nt lds
    buffer_load_dwordx4 v3, s[28:31], s59 offen offset:1024 nt lds
    buffer_load_dwordx4 v4, s[28:31], s59 offen offset:2048 nt lds
    buffer_load_dwordx4 v5, s[28:31], s59 offen offset:3072 nt lds
    s_mov_b32 m0, 73728
    s_mov_b32 s59, 253952
    buffer_load_dwordx4 v2, s[28:31], s59 offen offset:0 nt lds
    buffer_load_dwordx4 v3, s[28:31], s59 offen offset:1024 nt lds
    buffer_load_dwordx4 v4, s[28:31], s59 offen offset:2048 nt lds
    buffer_load_dwordx4 v5, s[28:31], s59 offen offset:3072 nt lds
    s_mov_b32 m0, 77824
    s_mov_b32 s59, 258048
    buffer_load_dwordx4 v2, s[28:31], s59 offen offset:0 nt lds
    buffer_load_dwordx4 v3, s[28:31], s59 offen offset:1024 nt lds
    buffer_load_dwordx4 v4, s[28:31], s59 offen offset:2048 nt lds
    buffer_load_dwordx4 v5, s[28:31], s59 offen offset:3072 nt lds
    s_mov_b32 m0, 81920
    s_mov_b32 s59, 229376
    buffer_load_dwordx4 v6, s[32:35], s59 offen offset:0 nt lds
    buffer_load_dwordx4 v6, s[32:35], s59 offen offset:1024 nt lds
    buffer_load_dwordx4 v6, s[32:35], s59 offen offset:2048 nt lds
    buffer_load_dwordx4 v6, s[32:35], s59 offen offset:3072 nt lds
    s_mov_b32 m0, 86016
    s_mov_b32 s59, 233472
    buffer_load_dwordx4 v6, s[32:35], s59 offen offset:0 nt lds
    buffer_load_dwordx4 v6, s[32:35], s59 offen offset:1024 nt lds
    buffer_load_dwordx4 v6, s[32:35], s59 offen offset:2048 nt lds
    buffer_load_dwordx4 v6, s[32:35], s59 offen offset:3072 nt lds
    s_mov_b32 m0, 90112
    s_mov_b32 s59, 237568
    buffer_load_dwordx4 v6, s[32:35], s59 offen offset:0 nt lds
    buffer_load_dwordx4 v6, s[32:35], s59 offen offset:1024 nt lds
    buffer_load_dwordx4 v6, s[32:35], s59 offen offset:2048 nt lds
    buffer_load_dwordx4 v6, s[32:35], s59 offen offset:3072 nt lds
    s_mov_b32 m0, 94208
    s_mov_b32 s59, 241664
    buffer_load_dwordx4 v6, s[32:35], s59 offen offset:0 nt lds
    buffer_load_dwordx4 v6, s[32:35], s59 offen offset:1024 nt lds
    buffer_load_dwordx4 v6, s[32:35], s59 offen offset:2048 nt lds
    buffer_load_dwordx4 v6, s[32:35], s59 offen offset:3072 nt lds
    s_waitcnt vmcnt(49)
    s_barrier
    s_mov_b32 m0, 98304
    s_mov_b32 s59, 245760
    buffer_load_dwordx4 v6, s[32:35], s59 offen offset:0 nt lds
    buffer_load_dwordx4 v6, s[32:35], s59 offen offset:1024 nt lds
    buffer_load_dwordx4 v6, s[32:35], s59 offen offset:2048 nt lds
    buffer_load_dwordx4 v6, s[32:35], s59 offen offset:3072 nt lds
    s_mov_b32 m0, 102400
    s_mov_b32 s59, 249856
    buffer_load_dwordx4 v6, s[32:35], s59 offen offset:0 nt lds
    buffer_load_dwordx4 v6, s[32:35], s59 offen offset:1024 nt lds
    buffer_load_dwordx4 v6, s[32:35], s59 offen offset:2048 nt lds
    buffer_load_dwordx4 v6, s[32:35], s59 offen offset:3072 nt lds
    s_mov_b32 m0, 106496
    s_mov_b32 s59, 253952
    buffer_load_dwordx4 v6, s[32:35], s59 offen offset:0 nt lds
    buffer_load_dwordx4 v6, s[32:35], s59 offen offset:1024 nt lds
    buffer_load_dwordx4 v6, s[32:35], s59 offen offset:2048 nt lds
    buffer_load_dwordx4 v6, s[32:35], s59 offen offset:3072 nt lds
    s_mov_b32 m0, 110592
    s_mov_b32 s59, 258048
    buffer_load_dwordx4 v6, s[32:35], s59 offen offset:0 nt lds
    buffer_load_dwordx4 v6, s[32:35], s59 offen offset:1024 nt lds
    buffer_load_dwordx4 v6, s[32:35], s59 offen offset:2048 nt lds
    buffer_load_dwordx4 v6, s[32:35], s59 offen offset:3072 nt lds
    s_waitcnt vmcnt(48)
    v_and_b32 v33, 0xffffff00, v33
    v_cmp_eq_u32 vcc, s65, v33
    s_nop 1
    s_and_b32 s57, vcc_lo, 0xf
    s_cmp_eq_u32 s57, 0xf
    s_cselect_b32 s62, 1, 0
    s_cmp_lg_u32 s71, 0
    s_cselect_b32 s62, s62, 0
    s_mov_b32 s63, 0
    v_mov_b32 v30, s62
    v_mov_b32 v31, s63
    v_mov_b32 v22, 162816
    ds_write_b64 v22, v[30:31]
    s_waitcnt lgkmcnt(0)
    s_waitcnt vmcnt(49)
    s_barrier
    s_add_u32 s59, s55, 0
    s_and_b32 s59, s59, 3
    s_mul_i32 s59, s59, 147456
    s_mov_b32 m0, 114688
    s_nop 0
    buffer_load_dwordx4 v10, s[36:39], s59 offen offset:0  lds
    buffer_load_dwordx4 v11, s[36:39], s59 offen offset:1024  lds
    buffer_load_dwordx4 v12, s[36:39], s59 offen offset:2048  lds
    buffer_load_dwordx4 v13, s[36:39], s59 offen offset:3072  lds
    s_mov_b32 m0, 118784
    s_nop 0
    buffer_load_dwordx4 v14, s[36:39], s59 offen offset:0  lds
    buffer_load_dwordx4 v15, s[36:39], s59 offen offset:1024  lds
    buffer_load_dwordx4 v16, s[36:39], s59 offen offset:2048  lds
    buffer_load_dwordx4 v17, s[36:39], s59 offen offset:3072  lds
    s_mov_b32 m0, 122880
    s_nop 0
    buffer_load_dwordx4 v18, s[36:39], s59 offen offset:0  lds
    s_add_u32 s59, s55, 0
    s_and_b32 s59, s59, 3
    s_mul_i32 s59, s59, 147456
    s_add_u32 s59, s59, 36864
    s_mov_b32 m0, 123904
    s_nop 0
    buffer_load_dwordx4 v10, s[36:39], s59 offen offset:0  lds
    buffer_load_dwordx4 v11, s[36:39], s59 offen offset:1024  lds
    buffer_load_dwordx4 v12, s[36:39], s59 offen offset:2048  lds
    buffer_load_dwordx4 v13, s[36:39], s59 offen offset:3072  lds
    s_mov_b32 m0, 128000
    s_nop 0
    buffer_load_dwordx4 v14, s[36:39], s59 offen offset:0  lds
    buffer_load_dwordx4 v15, s[36:39], s59 offen offset:1024  lds
    buffer_load_dwordx4 v16, s[36:39], s59 offen offset:2048  lds
    buffer_load_dwordx4 v17, s[36:39], s59 offen offset:3072  lds
    s_mov_b32 m0, 132096
    s_nop 0
    buffer_load_dwordx4 v18, s[36:39], s59 offen offset:0  lds
    s_add_u32 s59, s55, 0
    s_and_b32 s59, s59, 3
    s_mul_i32 s59, s59, 147456
    s_add_u32 s59, s59, 73728
    s_mov_b32 m0, 133120
    s_nop 0
    buffer_load_dwordx4 v10, s[36:39], s59 offen offset:0  lds
    buffer_load_dwordx4 v11, s[36:39], s59 offen offset:1024  lds
    buffer_load_dwordx4 v12, s[36:39], s59 offen offset:2048  lds
    buffer_load_dwordx4 v13, s[36:39], s59 offen offset:3072  lds
    s_mov_b32 m0, 137216
    s_nop 0
    buffer_load_dwordx4 v14, s[36:39], s59 offen offset:0  lds
    buffer_load_dwordx4 v15, s[36:39], s59 offen offset:1024  lds
    buffer_load_dwordx4 v16, s[36:39], s59 offen offset:2048  lds
    buffer_load_dwordx4 v17, s[36:39], s59 offen offset:3072  lds
    s_mov_b32 m0, 141312
    s_nop 0
    buffer_load_dwordx4 v18, s[36:39], s59 offen offset:0  lds
    s_waitcnt vmcnt(59)
    s_barrier
    s_add_u32 s59, s55, 0
    s_and_b32 s59, s59, 3
    s_mul_i32 s59, s59, 147456
    s_add_u32 s59, s59, 110592
    s_mov_b32 m0, 142336
    s_nop 0
    buffer_load_dwordx4 v10, s[36:39], s59 offen offset:0  lds
    buffer_load_dwordx4 v11, s[36:39], s59 offen offset:1024  lds
    buffer_load_dwordx4 v12, s[36:39], s59 offen offset:2048  lds
    buffer_load_dwordx4 v13, s[36:39], s59 offen offset:3072  lds
    s_mov_b32 m0, 146432
    s_nop 0
    buffer_load_dwordx4 v14, s[36:39], s59 offen offset:0  lds
    buffer_load_dwordx4 v15, s[36:39], s59 offen offset:1024  lds
    buffer_load_dwordx4 v16, s[36:39], s59 offen offset:2048  lds
    buffer_load_dwordx4 v17, s[36:39], s59 offen offset:3072  lds
    s_mov_b32 m0, 150528
    s_nop 0
    buffer_load_dwordx4 v18, s[36:39], s59 offen offset:0  lds
    s_add_u32 s59, s55, 1
    s_and_b32 s59, s59, 3
    s_mul_i32 s59, s59, 147456
    s_mov_b32 m0, 151552
    s_nop 0
    buffer_load_dwordx4 v10, s[36:39], s59 offen offset:0  lds
    buffer_load_dwordx4 v11, s[36:39], s59 offen offset:1024  lds
    buffer_load_dwordx4 v12, s[36:39], s59 offen offset:2048  lds
    buffer_load_dwordx4 v13, s[36:39], s59 offen offset:3072  lds
    s_mov_b32 m0, 155648
    s_nop 0
    buffer_load_dwordx4 v14, s[36:39], s59 offen offset:0  lds
    buffer_load_dwordx4 v15, s[36:39], s59 offen offset:1024  lds
    buffer_load_dwordx4 v16, s[36:39], s59 offen offset:2048  lds
    buffer_load_dwordx4 v17, s[36:39], s59 offen offset:3072  lds
    s_mov_b32 m0, 159744
    s_nop 0
    buffer_load_dwordx4 v18, s[36:39], s59 offen offset:0  lds
    s_waitcnt vmcnt(61)
    s_barrier
    s_waitcnt vmcnt(45)
    s_barrier
    s_add_u32 s59, s55, 1
    s_and_b32 s59, s59, 3
    s_mul_i32 s59, s59, 147456
    s_add_u32 s59, s59, 36864
    s_mov_b32 m0, 0
    s_nop 0
    buffer_load_dwordx4 v10, s[36:39], s59 offen offset:0  lds
    buffer_load_dwordx4 v11, s[36:39], s59 offen offset:1024  lds
    buffer_load_dwordx4 v12, s[36:39], s59 offen offset:2048  lds
    buffer_load_dwordx4 v13, s[36:39], s59 offen offset:3072  lds
    s_mov_b32 m0, 4096
    s_nop 0
    buffer_load_dwordx4 v14, s[36:39], s59 offen offset:0  lds
    buffer_load_dwordx4 v15, s[36:39], s59 offen offset:1024  lds
    buffer_load_dwordx4 v16, s[36:39], s59 offen offset:2048  lds
    buffer_load_dwordx4 v17, s[36:39], s59 offen offset:3072  lds
    s_mov_b32 m0, 8192
    s_nop 0
    buffer_load_dwordx4 v18, s[36:39], s59 offen offset:0  lds
    s_add_u32 s59, s55, 1
    s_and_b32 s59, s59, 3
    s_mul_i32 s59, s59, 147456
    s_add_u32 s59, s59, 73728
    s_mov_b32 m0, 9216
    s_nop 0
    buffer_load_dwordx4 v10, s[36:39], s59 offen offset:0  lds
    buffer_load_dwordx4 v11, s[36:39], s59 offen offset:1024  lds
    buffer_load_dwordx4 v12, s[36:39], s59 offen offset:2048  lds
    buffer_load_dwordx4 v13, s[36:39], s59 offen offset:3072  lds
    s_mov_b32 m0, 13312
    s_nop 0
    buffer_load_dwordx4 v14, s[36:39], s59 offen offset:0  lds
    buffer_load_dwordx4 v15, s[36:39], s59 offen offset:1024  lds
    buffer_load_dwordx4 v16, s[36:39], s59 offen offset:2048  lds
    buffer_load_dwordx4 v17, s[36:39], s59 offen offset:3072  lds
    s_mov_b32 m0, 17408
    s_nop 0
    buffer_load_dwordx4 v18, s[36:39], s59 offen offset:0  lds
    s_add_u32 s59, s55, 1
    s_and_b32 s59, s59, 3
    s_mul_i32 s59, s59, 147456
    s_add_u32 s59, s59, 110592
    s_mov_b32 m0, 18432
    s_nop 0
    buffer_load_dwordx4 v10, s[36:39], s59 offen offset:0  lds
    buffer_load_dwordx4 v11, s[36:39], s59 offen offset:1024  lds
    buffer_load_dwordx4 v12, s[36:39], s59 offen offset:2048  lds
    buffer_load_dwordx4 v13, s[36:39], s59 offen offset:3072  lds
    s_mov_b32 m0, 22528
    s_nop 0
    buffer_load_dwordx4 v14, s[36:39], s59 offen offset:0  lds
    buffer_load_dwordx4 v15, s[36:39], s59 offen offset:1024  lds
    buffer_load_dwordx4 v16, s[36:39], s59 offen offset:2048  lds
    buffer_load_dwordx4 v17, s[36:39], s59 offen offset:3072  lds
    s_mov_b32 m0, 26624
    s_nop 0
    buffer_load_dwordx4 v18, s[36:39], s59 offen offset:0  lds
    s_barrier
    s_add_u32 s59, s55, 2
    s_and_b32 s59, s59, 3
    s_mul_i32 s59, s59, 147456
    s_mov_b32 m0, 27648
    s_nop 0
    buffer_load_dwordx4 v10, s[36:39], s59 offen offset:0  lds
    buffer_load_dwordx4 v11, s[36:39], s59 offen offset:1024  lds
    buffer_load_dwordx4 v12, s[36:39], s59 offen offset:2048  lds
    buffer_load_dwordx4 v13, s[36:39], s59 offen offset:3072  lds
    s_mov_b32 m0, 31744
    s_nop 0
    buffer_load_dwordx4 v14, s[36:39], s59 offen offset:0  lds
    buffer_load_dwordx4 v15, s[36:39], s59 offen offset:1024  lds
    buffer_load_dwordx4 v16, s[36:39], s59 offen offset:2048  lds
    buffer_load_dwordx4 v17, s[36:39], s59 offen offset:3072  lds
    s_mov_b32 m0, 35840
    s_nop 0
    buffer_load_dwordx4 v18, s[36:39], s59 offen offset:0  lds
    s_add_u32 s59, s55, 2
    s_and_b32 s59, s59, 3
    s_mul_i32 s59, s59, 147456
    s_add_u32 s59, s59, 36864
    s_mov_b32 m0, 36864
    s_nop 0
    buffer_load_dwordx4 v10, s[36:39], s59 offen offset:0  lds
    buffer_load_dwordx4 v11, s[36:39], s59 offen offset:1024  lds
    buffer_load_dwordx4 v12, s[36:39], s59 offen offset:2048  lds
    buffer_load_dwordx4 v13, s[36:39], s59 offen offset:3072  lds
    s_mov_b32 m0, 40960
    s_nop 0
    buffer_load_dwordx4 v14, s[36:39], s59 offen offset:0  lds
    buffer_load_dwordx4 v15, s[36:39], s59 offen offset:1024  lds
    buffer_load_dwordx4 v16, s[36:39], s59 offen offset:2048  lds
    buffer_load_dwordx4 v17, s[36:39], s59 offen offset:3072  lds
    s_mov_b32 m0, 45056
    s_nop 0
    buffer_load_dwordx4 v18, s[36:39], s59 offen offset:0  lds
    s_add_u32 s59, s55, 2
    s_and_b32 s59, s59, 3
    s_mul_i32 s59, s59, 147456
    s_add_u32 s59, s59, 73728
    s_mov_b32 m0, 46080
    s_nop 0
    buffer_load_dwordx4 v10, s[36:39], s59 offen offset:0  lds
    buffer_load_dwordx4 v11, s[36:39], s59 offen offset:1024  lds
    buffer_load_dwordx4 v12, s[36:39], s59 offen offset:2048  lds
    buffer_load_dwordx4 v13, s[36:39], s59 offen offset:3072  lds
    s_mov_b32 m0, 50176
    s_nop 0
    buffer_load_dwordx4 v14, s[36:39], s59 offen offset:0  lds
    buffer_load_dwordx4 v15, s[36:39], s59 offen offset:1024  lds
    buffer_load_dwordx4 v16, s[36:39], s59 offen offset:2048  lds
    buffer_load_dwordx4 v17, s[36:39], s59 offen offset:3072  lds
    s_mov_b32 m0, 54272
    s_nop 0
    buffer_load_dwordx4 v18, s[36:39], s59 offen offset:0  lds
    s_add_u32 s59, s55, 2
    s_and_b32 s59, s59, 3
    s_mul_i32 s59, s59, 147456
    s_add_u32 s59, s59, 110592
    s_mov_b32 m0, 55296
    s_nop 0
    buffer_load_dwordx4 v10, s[36:39], s59 offen offset:0  lds
    buffer_load_dwordx4 v11, s[36:39], s59 offen offset:1024  lds
    buffer_load_dwordx4 v12, s[36:39], s59 offen offset:2048  lds
    buffer_load_dwordx4 v13, s[36:39], s59 offen offset:3072  lds
    s_mov_b32 m0, 59392
    s_nop 0
    buffer_load_dwordx4 v14, s[36:39], s59 offen offset:0  lds
    buffer_load_dwordx4 v15, s[36:39], s59 offen offset:1024  lds
    buffer_load_dwordx4 v16, s[36:39], s59 offen offset:2048  lds
    buffer_load_dwordx4 v17, s[36:39], s59 offen offset:3072  lds
    s_mov_b32 m0, 63488
    s_nop 0
    buffer_load_dwordx4 v18, s[36:39], s59 offen offset:0  lds
    s_cmp_lg_u32 s71, 0
    s_cbranch_scc1 L_rok_l2
    s_mov_b64 exec, 0x1
    s_mov_b32 s68, 0
L_poll_l3:
    buffer_load_dword v22, v28, s[48:51], 0 offen sc1
    s_waitcnt vmcnt(0)
    v_cmp_le_u32 vcc, 1, v22
    s_add_u32 s68, s68, 1
    s_nop 2
    s_cmp_eq_u64 vcc, exec
    s_cbranch_scc1 L_pdone_l4
    s_cmp_lt_u32 s68, 0x8000
    s_cbranch_scc1 L_poll_l3
L_pdone_l4:
    s_mov_b64 exec, -1
L_rok_l2:
    s_barrier
    s_add_u32 s59, s55, 3
    s_and_b32 s59, s59, 3
    s_mul_i32 s59, s59, 147456
    s_mov_b32 m0, 64512
    s_nop 0
    buffer_load_dwordx4 v10, s[36:39], s59 offen offset:0  lds
    buffer_load_dwordx4 v11, s[36:39], s59 offen offset:1024  lds
    buffer_load_dwordx4 v12, s[36:39], s59 offen offset:2048  lds
    buffer_load_dwordx4 v13, s[36:39], s59 offen offset:3072  lds
    s_mov_b32 m0, 68608
    s_nop 0
    buffer_load_dwordx4 v14, s[36:39], s59 offen offset:0  lds
    buffer_load_dwordx4 v15, s[36:39], s59 offen offset:1024  lds
    buffer_load_dwordx4 v16, s[36:39], s59 offen offset:2048  lds
    buffer_load_dwordx4 v17, s[36:39], s59 offen offset:3072  lds
    s_mov_b32 m0, 72704
    s_nop 0
    buffer_load_dwordx4 v18, s[36:39], s59 offen offset:0  lds
    s_add_u32 s59, s55, 3
    s_and_b32 s59, s59, 3
    s_mul_i32 s59, s59, 147456
    s_add_u32 s59, s59, 36864
    s_mov_b32 m0, 73728
    s_nop 0
    buffer_load_dwordx4 v10, s[36:39], s59 offen offset:0  lds
    buffer_load_dwordx4 v11, s[36:39], s59 offen offset:1024  lds
    buffer_load_dwordx4 v12, s[36:39], s59 offen offset:2048  lds
    buffer_load_dwordx4 v13, s[36:39], s59 offen offset:3072  lds
    s_mov_b32 m0, 77824
    s_nop 0
    buffer_load_dwordx4 v14, s[36:39], s59 offen offset:0  lds
    buffer_load_dwordx4 v15, s[36:39], s59 offen offset:1024  lds
    buffer_load_dwordx4 v16, s[36:39], s59 offen offset:2048  lds
    buffer_load_dwordx4 v17, s[36:39], s59 offen offset:3072  lds
    s_mov_b32 m0, 81920
    s_nop 0
    buffer_load_dwordx4 v18, s[36:39], s59 offen offset:0  lds
    s_add_u32 s59, s55, 3
    s_and_b32 s59, s59, 3
    s_mul_i32 s59, s59, 147456
    s_add_u32 s59, s59, 73728
    s_mov_b32 m0, 82944
    s_nop 0
    buffer_load_dwordx4 v10, s[36:39], s59 offen offset:0  lds
    buffer_load_dwordx4 v11, s[36:39], s59 offen offset:1024  lds
    buffer_load_dwordx4 v12, s[36:39], s59 offen offset:2048  lds
    buffer_load_dwordx4 v13, s[36:39], s59 offen offset:3072  lds
    s_mov_b32 m0, 87040
    s_nop 0
    buffer_load_dwordx4 v14, s[36:39], s59 offen offset:0  lds
    buffer_load_dwordx4 v15, s[36:39], s59 offen offset:1024  lds
    buffer_load_dwordx4 v16, s[36:39], s59 offen offset:2048  lds
    buffer_load_dwordx4 v17, s[36:39], s59 offen offset:3072  lds
    s_mov_b32 m0, 91136
    s_nop 0
    buffer_load_dwordx4 v18, s[36:39], s59 offen offset:0  lds
    s_add_u32 s59, s55, 3
    s_and_b32 s59, s59, 3
    s_mul_i32 s59, s59, 147456
    s_add_u32 s59, s59, 110592
    s_mov_b32 m0, 92160
    s_nop 0
    buffer_load_dwordx4 v10, s[36:39], s59 offen offset:0  lds
    buffer_load_dwordx4 v11, s[36:39], s59 offen offset:1024  lds
    buffer_load_dwordx4 v12, s[36:39], s59 offen offset:2048  lds
    buffer_load_dwordx4 v13, s[36:39], s59 offen offset:3072  lds
    s_mov_b32 m0, 96256
    s_nop 0
    buffer_load_dwordx4 v14, s[36:39], s59 offen offset:0  lds
    buffer_load_dwordx4 v15, s[36:39], s59 offen offset:1024  lds
    buffer_load_dwordx4 v16, s[36:39], s59 offen offset:2048  lds
    buffer_load_dwordx4 v17, s[36:39], s59 offen offset:3072  lds
    s_mov_b32 m0, 100352
    s_nop 0
    buffer_load_dwordx4 v18, s[36:39], s59 offen offset:0  lds
    s_waitcnt vmcnt(36)
    s_barrier
    s_or_b32 s57, s65, 1
    v_mov_b32 v21, s57
    s_mov_b64 exec, 1
    s_cmp_eq_u32 s62, 0
    s_cbranch_scc1 L_fs_l5
    buffer_store_dword v21, v24, s[40:43], 0 offen
    s_branch L_fj_l6
L_fs_l5:
    buffer_store_dword v21, v24, s[40:43], 0 offen sc1
L_fj_l6:
    s_mov_b64 exec, -1
    s_mov_b64 exec, 0xf
    s_mov_b32 s68, 0
L_poll_l7:
    buffer_load_dword v22, v26, s[40:43], 0 offen sc1
    s_waitcnt vmcnt(0)
    v_and_b32 v22, 1, v22
    v_cmp_le_u32 vcc, 1, v22
    s_add_u32 s68, s68, 1
    s_nop 2
    s_cmp_eq_u64 vcc, exec
    s_cbranch_scc1 L_pdone_l8
    s_cmp_lt_u32 s68, 0x8000
    s_cbranch_scc1 L_poll_l7
L_pdone_l8:
    s_mov_b64 exec, -1
    s_barrier
    s_barrier
    s_or_b32 s57, s65, 1
    v_mov_b32 v21, s57
    s_mov_b64 exec, 1
    buffer_store_dword v21, v25, s[40:43], 0 offen sc1
    s_mov_b64 exec, -1
    s_mov_b64 exec, 0xff
    s_mov_b32 s68, 0
L_poll_l9:
    buffer_load_dword v22, v27, s[40:43], 0 offen sc1
    s_waitcnt vmcnt(0)
    v_and_b32 v22, 1, v22
    v_cmp_le_u32 vcc, 1, v22
    s_add_u32 s68, s68, 1
    s_nop 2
    s_cmp_eq_u64 vcc, exec
    s_cbranch_scc1 L_pdone_l10
    s_cmp_lt_u32 s68, 0x8000
    s_cbranch_scc1 L_poll_l9
L_pdone_l10:
    s_mov_b64 exec, -1
    s_barrier
    s_endpgm
L_compute:
    s_and_b32 s69, s52, 1
    s_lshr_b32 s70, s52, 1
    s_lshl_b32 s63, s52, 12
    s_waitcnt lgkmcnt(0)
    s_add_u32 s20, s4, s57
    s_addc_u32 s21, s5, 0
    s_add_u32 s24, s10, s58
    s_addc_u32 s25, s11, 0
    s_add_u32 s28, s6, s64
    s_addc_u32 s29, s7, 0
    s_add_u32 s32, s8, s64
    s_addc_u32 s33, s9, 0
    s_mov_b32 s40, s18
    s_mov_b32 s41, s19
    s_mov_b32 s66, 0x3e0293ee
    s_mov_b32 s67, 0x41000000
    s_mov_b32 s44, s14
    s_mov_b32 s45, s15
    s_mov_b32 s46, 589824
    s_mov_b32 s47, 0x20000
    v_lshrrev_b32 v18, 4, v1
    v_and_b32 v19, 15, v1
    v_lshrrev_b32 v20, 2, v19
    v_and_b32 v21, 3, v1
    v_and_b32 v22, 1, v18
    v_lshrrev_b32 v23, 1, v18
    v_lshl_add_u32 v24, v23, 3, v20
    v_lshlrev_b32 v24, 8, v24
    v_xor_b32 v25, s52, v20
    v_lshl_add_u32 v24, v25, 6, v24
    v_lshl_add_u32 v24, v22, 5, v24
    v_and_b32 v25, 1, v21
    v_lshl_add_u32 v24, v25, 4, v24
    v_lshrrev_b32 v25, 1, v21
    v_lshl_add_u32 v30, v25, 3, v24
    v_and_b32 v26, 31, v1
    v_lshrrev_b32 v27, 5, v1
    v_lshrrev_b32 v28, 1, v26
    v_and_b32 v28, 7, v28
    v_xor_b32 v28, v28, v27
    v_lshlrev_b32 v29, 7, v26
    v_add_u32 v29, 16384, v29
    v_xor_b32 v27, 0, v28
    v_lshl_add_u32 v31, v27, 4, v29
    v_xor_b32 v27, 2, v28
    v_lshl_add_u32 v32, v27, 4, v29
    v_xor_b32 v27, 4, v28
    v_lshl_add_u32 v33, v27, 4, v29
    v_xor_b32 v27, 6, v28
    v_lshl_add_u32 v34, v27, 4, v29
    v_lshlrev_b32 v14, 4, v1
    s_and_b32 s68, s56, 31
    s_lshl_b32 s68, s68, 2
    s_add_u32 s68, s68, s52
    s_cmp_lg_u32 s68, 3
    s_cbranch_scc1 L_rst_c4
    v_and_b32 v18, 31, v1
    v_add_u32 v18, s56, v18
    v_lshlrev_b32 v18, 7, v18
    v_lshrrev_b32 v19, 5, v1
    v_lshl_add_u32 v18, v19, 15, v18
    v_mov_b32 v19, 0
    buffer_store_dword v19, v18, s[40:43], 0 offen sc1
    s_waitcnt vmcnt(0)
    s_mov_b32 s48, s16
    s_mov_b32 s49, s17
    s_mov_b32 s50, 256
    s_mov_b32 s51, 0x20000
    s_lshl_b32 s68, s53, 2
    v_mov_b32 v18, s68
    v_mov_b32 v19, 1
    s_mov_b64 exec, 1
    buffer_store_dword v19, v18, s[48:51], 0 offen sc1
    s_mov_b64 exec, -1
L_rst_c4:
    v_lshrrev_b32 v18, 4, v1
    v_and_b32 v19, 15, v1
    v_lshrrev_b32 v20, 2, v19
    v_and_b32 v21, 3, v1
    v_and_b32 v22, 1, v18
    v_lshrrev_b32 v23, 1, v18
    v_lshl_add_u32 v24, v23, 2, v20
    v_lshlrev_b32 v24, 8, v24
    v_lshl_add_u32 v24, v22, 5, v24
    v_lshl_add_u32 v24, v21, 3, v24
    s_lshl_b32 s57, s70, 13
    v_add_u32 v24, s57, v24
    s_lshl_b32 s58, s70, 1
    s_xor_b32 s64, s58, 0
    v_xor_b32 v25, s64, v20
    v_lshl_add_u32 v10, v25, 6, v24
    s_xor_b32 s64, s58, 1
    v_xor_b32 v25, s64, v20
    v_lshl_add_u32 v11, v25, 6, v24
    s_xor_b32 s64, s58, 2
    v_xor_b32 v25, s64, v20
    v_lshl_add_u32 v12, v25, 6, v24
    s_xor_b32 s64, s58, 3
    v_xor_b32 v25, s64, v20
    v_lshl_add_u32 v13, v25, 6, v24
    v_and_b32 v26, 31, v1
    v_lshrrev_b32 v27, 5, v1
    v_and_b32 v28, 15, v26
    v_xor_b32 v28, v28, v27
    v_lshlrev_b32 v29, 8, v26
    v_add_u32 v29, s57, v29
    v_xor_b32 v27, 0, v28
    v_lshl_add_u32 v2, v27, 4, v29
    v_xor_b32 v27, 2, v28
    v_lshl_add_u32 v3, v27, 4, v29
    v_xor_b32 v27, 4, v28
    v_lshl_add_u32 v4, v27, 4, v29
    v_xor_b32 v27, 6, v28
    v_lshl_add_u32 v5, v27, 4, v29
    v_xor_b32 v27, 8, v28
    v_lshl_add_u32 v6, v27, 4, v29
    v_xor_b32 v27, 10, v28
    v_lshl_add_u32 v7, v27, 4, v29
    v_xor_b32 v27, 12, v28
    v_lshl_add_u32 v8, v27, 4, v29
    v_xor_b32 v27, 14, v28
    v_lshl_add_u32 v9, v27, 4, v29
    v_lshlrev_b32 v18, 3, v1
    s_lshl_b32 s57, s52, 9
    s_add_u32 s57, s57, 160768
    v_add_u32 v35, s57, v18
    s_xor_b32 s58, s52, 2
    s_lshl_b32 s57, s58, 9
    s_add_u32 s57, s57, 160768
    v_add_u32 v36, s57, v18
    s_lshl_b32 s57, s52, 13
    s_add_u32 s57, s57, 65536
    v_add_u32 v37, s57, v14
    s_lshl_b32 s57, s58, 13
    s_add_u32 s57, s57, 65536
    v_add_u32 v38, s57, v14
    v_and_b32 v18, 31, v1
    v_lshrrev_b32 v19, 4, v18
    v_lshlrev_b32 v19, 12, v19
    v_and_b32 v20, 15, v18
    v_lshl_add_u32 v19, v20, 4, v19
    v_lshrrev_b32 v20, 5, v1
    v_lshl_add_u32 v19, v20, 8, v19
    s_lshl_b32 s57, s56, 14
    s_lshl_b32 s58, s69, 13
    s_add_u32 s57, s57, s58
    s_lshl_b32 s58, s70, 11
    s_add_u32 s57, s57, s58
    s_add_u32 s57, s57, 1048576
    v_add_u32 v39, s57, v19
    s_barrier
    ds_read_b64_tr_b16 a[0:1], v30 offset:0
    ds_read_b64_tr_b16 a[2:3], v30 offset:1024
    ds_read_b128 a[16:19], v31 offset:0
    ds_read_b128 a[20:23], v31 offset:4096
    ds_read_b64_tr_b16 a[4:5], v30 offset:4096
    ds_read_b64_tr_b16 a[6:7], v30 offset:5120
    ds_read_b128 a[24:27], v32 offset:0
    ds_read_b128 a[28:31], v32 offset:4096
    ds_read_b64_tr_b16 a[8:9], v30 offset:8192
    ds_read_b64_tr_b16 a[10:11], v30 offset:9216
    ds_read_b128 a[32:35], v33 offset:0
    ds_read_b128 a[36:39], v33 offset:4096
    ds_read_b64_tr_b16 a[12:13], v30 offset:12288
    ds_read_b64_tr_b16 a[14:15], v30 offset:13312
    ds_read_b128 a[40:43], v34 offset:0
    ds_read_b128 a[44:47], v34 offset:4096
    s_waitcnt lgkmcnt(0)
    s_barrier
    ds_read_b64_tr_b16 a[48:49], v30 offset:24576
    ds_read_b64_tr_b16 a[50:51], v30 offset:25600
    v_mfma_f32_32x32x16_bf16 v[48:63], a[0:3], a[16:19], 0
    ds_read_b128 a[64:67], v31 offset:24576
    ds_read_b128 a[68:71], v31 offset:28672
    v_mfma_f32_32x32x16_bf16 v[64:79], a[0:3], a[20:23], 0
    ds_read_b64_tr_b16 a[52:53], v30 offset:28672
    ds_read_b64_tr_b16 a[54:55], v30 offset:29696
    v_mfma_f32_32x32x16_bf16 v[48:63], a[4:7], a[24:27], v[48:63]
    ds_read_b128 a[72:75], v32 offset:24576
    ds_read_b128 a[76:79], v32 offset:28672
    v_mfma_f32_32x32x16_bf16 v[64:79], a[4:7], a[28:31], v[64:79]
    ds_read_b64_tr_b16 a[56:57], v30 offset:32768
    ds_read_b64_tr_b16 a[58:59], v30 offset:33792
    v_mfma_f32_32x32x16_bf16 v[48:63], a[8:11], a[32:35], v[48:63]
    ds_read_b128 a[80:83], v33 offset:24576
    ds_read_b128 a[84:87], v33 offset:28672
    v_mfma_f32_32x32x16_bf16 v[64:79], a[8:11], a[36:39], v[64:79]
    ds_read_b64_tr_b16 a[60:61], v30 offset:36864
    ds_read_b64_tr_b16 a[62:63], v30 offset:37888
    v_mfma_f32_32x32x16_bf16 v[48:63], a[12:15], a[40:43], v[48:63]
    ds_read_b128 a[88:91], v34 offset:24576
    ds_read_b128 a[92:95], v34 offset:28672
    v_mfma_f32_32x32x16_bf16 v[64:79], a[12:15], a[44:47], v[64:79]
    s_waitcnt lgkmcnt(0)
    s_barrier
    ds_read_b64_tr_b16 a[0:1], v30 offset:49152
    ds_read_b64_tr_b16 a[2:3], v30 offset:50176
    v_mfma_f32_32x32x16_bf16 v[48:63], a[48:51], a[64:67], v[48:63]
    ds_read_b128 a[16:19], v31 offset:49152
    ds_read_b128 a[20:23], v31 offset:53248
    v_mfma_f32_32x32x16_bf16 v[64:79], a[48:51], a[68:71], v[64:79]
    ds_read_b64_tr_b16 a[4:5], v30 offset:53248
    ds_read_b64_tr_b16 a[6:7], v30 offset:54272
    v_mfma_f32_32x32x16_bf16 v[48:63], a[52:55], a[72:75], v[48:63]
    ds_read_b128 a[24:27], v32 offset:49152
    ds_read_b128 a[28:31], v32 offset:53248
    v_mfma_f32_32x32x16_bf16 v[64:79], a[52:55], a[76:79], v[64:79]
    ds_read_b64_tr_b16 a[8:9], v30 offset:57344
    ds_read_b64_tr_b16 a[10:11], v30 offset:58368
    v_mfma_f32_32x32x16_bf16 v[48:63], a[56:59], a[80:83], v[48:63]
    ds_read_b128 a[32:35], v33 offset:49152
    ds_read_b128 a[36:39], v33 offset:53248
    v_mfma_f32_32x32x16_bf16 v[64:79], a[56:59], a[84:87], v[64:79]
    ds_read_b64_tr_b16 a[12:13], v30 offset:61440
    ds_read_b64_tr_b16 a[14:15], v30 offset:62464
    v_mfma_f32_32x32x16_bf16 v[48:63], a[60:63], a[88:91], v[48:63]
    ds_read_b128 a[40:43], v34 offset:49152
    ds_read_b128 a[44:47], v34 offset:53248
    v_mfma_f32_32x32x16_bf16 v[64:79], a[60:63], a[92:95], v[64:79]
    s_waitcnt lgkmcnt(0)
    s_barrier
    ds_read_b64_tr_b16 a[48:49], v30 offset:0
    ds_read_b64_tr_b16 a[50:51], v30 offset:1024
    v_mfma_f32_32x32x16_bf16 v[48:63], a[0:3], a[16:19], v[48:63]
    ds_read_b128 a[64:67], v31 offset:0
    ds_read_b128 a[68:71], v31 offset:4096
    v_mfma_f32_32x32x16_bf16 v[64:79], a[0:3], a[20:23], v[64:79]
    ds_read_b64_tr_b16 a[52:53], v30 offset:4096
    ds_read_b64_tr_b16 a[54:55], v30 offset:5120
    v_mfma_f32_32x32x16_bf16 v[48:63], a[4:7], a[24:27], v[48:63]
    ds_read_b128 a[72:75], v32 offset:0
    ds_read_b128 a[76:79], v32 offset:4096
    v_mfma_f32_32x32x16_bf16 v[64:79], a[4:7], a[28:31], v[64:79]
    ds_read_b64_tr_b16 a[56:57], v30 offset:8192
    ds_read_b64_tr_b16 a[58:59], v30 offset:9216
    v_mfma_f32_32x32x16_bf16 v[48:63], a[8:11], a[32:35], v[48:63]
    ds_read_b128 a[80:83], v33 offset:0
    ds_read_b128 a[84:87], v33 offset:4096
    v_mfma_f32_32x32x16_bf16 v[64:79], a[8:11], a[36:39], v[64:79]
    ds_read_b64_tr_b16 a[60:61], v30 offset:12288
    ds_read_b64_tr_b16 a[62:63], v30 offset:13312
    v_mfma_f32_32x32x16_bf16 v[48:63], a[12:15], a[40:43], v[48:63]
    ds_read_b128 a[88:91], v34 offset:0
    ds_read_b128 a[92:95], v34 offset:4096
    v_mfma_f32_32x32x16_bf16 v[64:79], a[12:15], a[44:47], v[64:79]
    s_waitcnt lgkmcnt(0)
    s_barrier
    ds_read_b64_tr_b16 a[0:1], v30 offset:24576
    ds_read_b64_tr_b16 a[2:3], v30 offset:25600
    v_mfma_f32_32x32x16_bf16 v[48:63], a[48:51], a[64:67], v[48:63]
    ds_read_b128 a[16:19], v31 offset:24576
    ds_read_b128 a[20:23], v31 offset:28672
    v_mfma_f32_32x32x16_bf16 v[64:79], a[48:51], a[68:71], v[64:79]
    ds_read_b64_tr_b16 a[4:5], v30 offset:28672
    ds_read_b64_tr_b16 a[6:7], v30 offset:29696
    v_mfma_f32_32x32x16_bf16 v[48:63], a[52:55], a[72:75], v[48:63]
    ds_read_b128 a[24:27], v32 offset:24576
    ds_read_b128 a[28:31], v32 offset:28672
    v_mfma_f32_32x32x16_bf16 v[64:79], a[52:55], a[76:79], v[64:79]
    ds_read_b64_tr_b16 a[8:9], v30 offset:32768
    ds_read_b64_tr_b16 a[10:11], v30 offset:33792
    v_mfma_f32_32x32x16_bf16 v[48:63], a[56:59], a[80:83], v[48:63]
    ds_read_b128 a[32:35], v33 offset:24576
    ds_read_b128 a[36:39], v33 offset:28672
    v_mfma_f32_32x32x16_bf16 v[64:79], a[56:59], a[84:87], v[64:79]
    ds_read_b64_tr_b16 a[12:13], v30 offset:36864
    ds_read_b64_tr_b16 a[14:15], v30 offset:37888
    v_mfma_f32_32x32x16_bf16 v[48:63], a[60:63], a[88:91], v[48:63]
    ds_read_b128 a[40:43], v34 offset:24576
    ds_read_b128 a[44:47], v34 offset:28672
    v_mfma_f32_32x32x16_bf16 v[64:79], a[60:63], a[92:95], v[64:79]
    s_waitcnt lgkmcnt(0)
    s_barrier
    ds_read_b64_tr_b16 a[48:49], v30 offset:49152
    ds_read_b64_tr_b16 a[50:51], v30 offset:50176
    v_mfma_f32_32x32x16_bf16 v[48:63], a[0:3], a[16:19], v[48:63]
    ds_read_b128 a[64:67], v31 offset:49152
    ds_read_b128 a[68:71], v31 offset:53248
    v_mfma_f32_32x32x16_bf16 v[64:79], a[0:3], a[20:23], v[64:79]
    ds_read_b64_tr_b16 a[52:53], v30 offset:53248
    ds_read_b64_tr_b16 a[54:55], v30 offset:54272
    v_mfma_f32_32x32x16_bf16 v[48:63], a[4:7], a[24:27], v[48:63]
    ds_read_b128 a[72:75], v32 offset:49152
    ds_read_b128 a[76:79], v32 offset:53248
    v_mfma_f32_32x32x16_bf16 v[64:79], a[4:7], a[28:31], v[64:79]
    ds_read_b64_tr_b16 a[56:57], v30 offset:57344
    ds_read_b64_tr_b16 a[58:59], v30 offset:58368
    v_mfma_f32_32x32x16_bf16 v[48:63], a[8:11], a[32:35], v[48:63]
    ds_read_b128 a[80:83], v33 offset:49152
    ds_read_b128 a[84:87], v33 offset:53248
    v_mfma_f32_32x32x16_bf16 v[64:79], a[8:11], a[36:39], v[64:79]
    ds_read_b64_tr_b16 a[60:61], v30 offset:61440
    ds_read_b64_tr_b16 a[62:63], v30 offset:62464
    v_mfma_f32_32x32x16_bf16 v[48:63], a[12:15], a[40:43], v[48:63]
    ds_read_b128 a[88:91], v34 offset:49152
    ds_read_b128 a[92:95], v34 offset:53248
    v_mfma_f32_32x32x16_bf16 v[64:79], a[12:15], a[44:47], v[64:79]
    s_waitcnt lgkmcnt(0)
    s_barrier
    ds_read_b64_tr_b16 a[0:1], v30 offset:0
    ds_read_b64_tr_b16 a[2:3], v30 offset:1024
    v_mfma_f32_32x32x16_bf16 v[48:63], a[48:51], a[64:67], v[48:63]
    ds_read_b128 a[16:19], v31 offset:0
    ds_read_b128 a[20:23], v31 offset:4096
    v_mfma_f32_32x32x16_bf16 v[64:79], a[48:51], a[68:71], v[64:79]
    ds_read_b64_tr_b16 a[4:5], v30 offset:4096
    ds_read_b64_tr_b16 a[6:7], v30 offset:5120
    v_mfma_f32_32x32x16_bf16 v[48:63], a[52:55], a[72:75], v[48:63]
    ds_read_b128 a[24:27], v32 offset:0
    ds_read_b128 a[28:31], v32 offset:4096
    v_mfma_f32_32x32x16_bf16 v[64:79], a[52:55], a[76:79], v[64:79]
    ds_read_b64_tr_b16 a[8:9], v30 offset:8192
    ds_read_b64_tr_b16 a[10:11], v30 offset:9216
    v_mfma_f32_32x32x16_bf16 v[48:63], a[56:59], a[80:83], v[48:63]
    ds_read_b128 a[32:35], v33 offset:0
    ds_read_b128 a[36:39], v33 offset:4096
    v_mfma_f32_32x32x16_bf16 v[64:79], a[56:59], a[84:87], v[64:79]
    ds_read_b64_tr_b16 a[12:13], v30 offset:12288
    ds_read_b64_tr_b16 a[14:15], v30 offset:13312
    v_mfma_f32_32x32x16_bf16 v[48:63], a[60:63], a[88:91], v[48:63]
    ds_read_b128 a[40:43], v34 offset:0
    ds_read_b128 a[44:47], v34 offset:4096
    v_mfma_f32_32x32x16_bf16 v[64:79], a[60:63], a[92:95], v[64:79]
    s_waitcnt lgkmcnt(0)
    s_barrier
    ds_read_b64_tr_b16 a[48:49], v30 offset:24576
    ds_read_b64_tr_b16 a[50:51], v30 offset:25600
    v_mfma_f32_32x32x16_bf16 v[48:63], a[0:3], a[16:19], v[48:63]
    ds_read_b128 a[64:67], v31 offset:24576
    ds_read_b128 a[68:71], v31 offset:28672
    v_mfma_f32_32x32x16_bf16 v[64:79], a[0:3], a[20:23], v[64:79]
    ds_read_b64_tr_b16 a[52:53], v30 offset:28672
    ds_read_b64_tr_b16 a[54:55], v30 offset:29696
    v_mfma_f32_32x32x16_bf16 v[48:63], a[4:7], a[24:27], v[48:63]
    ds_read_b128 a[72:75], v32 offset:24576
    ds_read_b128 a[76:79], v32 offset:28672
    v_mfma_f32_32x32x16_bf16 v[64:79], a[4:7], a[28:31], v[64:79]
    ds_read_b64_tr_b16 a[56:57], v30 offset:32768
    ds_read_b64_tr_b16 a[58:59], v30 offset:33792
    v_mfma_f32_32x32x16_bf16 v[48:63], a[8:11], a[32:35], v[48:63]
    ds_read_b128 a[80:83], v33 offset:24576
    ds_read_b128 a[84:87], v33 offset:28672
    v_mfma_f32_32x32x16_bf16 v[64:79], a[8:11], a[36:39], v[64:79]
    ds_read_b64_tr_b16 a[60:61], v30 offset:36864
    ds_read_b64_tr_b16 a[62:63], v30 offset:37888
    v_mfma_f32_32x32x16_bf16 v[48:63], a[12:15], a[40:43], v[48:63]
    ds_read_b128 a[88:91], v34 offset:24576
    ds_read_b128 a[92:95], v34 offset:28672
    v_mfma_f32_32x32x16_bf16 v[64:79], a[12:15], a[44:47], v[64:79]
    s_waitcnt lgkmcnt(0)
    s_barrier
    ds_read_b64_tr_b16 a[0:1], v30 offset:49152
    ds_read_b64_tr_b16 a[2:3], v30 offset:50176
    v_mfma_f32_32x32x16_bf16 v[48:63], a[48:51], a[64:67], v[48:63]
    ds_read_b128 a[16:19], v31 offset:49152
    ds_read_b128 a[20:23], v31 offset:53248
    v_mfma_f32_32x32x16_bf16 v[64:79], a[48:51], a[68:71], v[64:79]
    ds_read_b64_tr_b16 a[4:5], v30 offset:53248
    ds_read_b64_tr_b16 a[6:7], v30 offset:54272
    v_mfma_f32_32x32x16_bf16 v[48:63], a[52:55], a[72:75], v[48:63]
    ds_read_b128 a[24:27], v32 offset:49152
    ds_read_b128 a[28:31], v32 offset:53248
    v_mfma_f32_32x32x16_bf16 v[64:79], a[52:55], a[76:79], v[64:79]
    ds_read_b64_tr_b16 a[8:9], v30 offset:57344
    ds_read_b64_tr_b16 a[10:11], v30 offset:58368
    v_mfma_f32_32x32x16_bf16 v[48:63], a[56:59], a[80:83], v[48:63]
    ds_read_b128 a[32:35], v33 offset:49152
    ds_read_b128 a[36:39], v33 offset:53248
    v_mfma_f32_32x32x16_bf16 v[64:79], a[56:59], a[84:87], v[64:79]
    ds_read_b64_tr_b16 a[12:13], v30 offset:61440
    ds_read_b64_tr_b16 a[14:15], v30 offset:62464
    v_mfma_f32_32x32x16_bf16 v[48:63], a[60:63], a[88:91], v[48:63]
    ds_read_b128 a[40:43], v34 offset:49152
    ds_read_b128 a[44:47], v34 offset:53248
    v_mfma_f32_32x32x16_bf16 v[64:79], a[60:63], a[92:95], v[64:79]
    s_waitcnt lgkmcnt(0)
    v_mfma_f32_32x32x16_bf16 v[48:63], a[0:3], a[16:19], v[48:63]
    v_mfma_f32_32x32x16_bf16 v[64:79], a[0:3], a[20:23], v[64:79]
    v_mfma_f32_32x32x16_bf16 v[48:63], a[4:7], a[24:27], v[48:63]
    v_mfma_f32_32x32x16_bf16 v[64:79], a[4:7], a[28:31], v[64:79]
    v_mfma_f32_32x32x16_bf16 v[48:63], a[8:11], a[32:35], v[48:63]
    v_mfma_f32_32x32x16_bf16 v[64:79], a[8:11], a[36:39], v[64:79]
    v_mfma_f32_32x32x16_bf16 v[48:63], a[12:15], a[40:43], v[48:63]
    v_mfma_f32_32x32x16_bf16 v[64:79], a[12:15], a[44:47], v[64:79]
    s_waitcnt vmcnt(0)
    s_barrier
    s_lshl_b32 s57, s52, 11
    s_add_u32 s57, s57, 65536
    v_add_u32 v18, s57, v14
    s_lshl_b32 s57, s69, 13
    s_add_u32 s57, s57, 65536
    v_add_u32 v19, s57, v14
    s_nop 7
    v_cvt_pk_bf16_f32 v96, v48, v49
    v_cvt_pk_bf16_f32 v97, v50, v51
    v_cvt_pk_bf16_f32 v98, v52, v53
    v_cvt_pk_bf16_f32 v99, v54, v55
    v_cvt_pk_bf16_f32 v100, v56, v57
    v_cvt_pk_bf16_f32 v101, v58, v59
    v_cvt_pk_bf16_f32 v102, v60, v61
    v_cvt_pk_bf16_f32 v103, v62, v63
    v_cvt_pk_bf16_f32 v104, v64, v65
    v_cvt_pk_bf16_f32 v105, v66, v67
    v_cvt_pk_bf16_f32 v106, v68, v69
    v_cvt_pk_bf16_f32 v107, v70, v71
    v_cvt_pk_bf16_f32 v108, v72, v73
    v_cvt_pk_bf16_f32 v109, v74, v75
    v_cvt_pk_bf16_f32 v110, v76, v77
    v_cvt_pk_bf16_f32 v111, v78, v79
    ds_write_b128 v18, v[96:99] offset:0
    ds_write_b128 v18, v[100:103] offset:1024
    ds_write_b128 v18, v[104:107] offset:8192
    ds_write_b128 v18, v[108:111] offset:9216
    s_waitcnt lgkmcnt(0)
    s_barrier
    ds_read_b128 a[0:3], v19 offset:0
    ds_read_b128 a[4:7], v19 offset:1024
    ds_read_b128 a[8:11], v19 offset:2048
    ds_read_b128 a[12:15], v19 offset:3072
    ds_read_b128 a[16:19], v19 offset:4096
    ds_read_b128 a[20:23], v19 offset:5120
    ds_read_b128 a[24:27], v19 offset:6144
    ds_read_b128 a[28:31], v19 offset:7168
    s_waitcnt lgkmcnt(0)
    v_add_u32 v2, 0x10000, v2
    v_add_u32 v3, 0x10000, v3
    v_add_u32 v4, 0x10000, v4
    v_add_u32 v5, 0x10000, v5
    v_add_u32 v6, 0x10000, v6
    v_add_u32 v7, 0x10000, v7
    v_add_u32 v8, 0x10000, v8
    v_add_u32 v9, 0x10000, v9
    s_barrier
    ds_read_b128 a[32:35], v2 offset:16384
    ds_read_b128 a[36:39], v3 offset:16384
    ds_read_b128 a[40:43], v4 offset:16384
    ds_read_b128 a[44:47], v5 offset:16384
    ds_read_b128 a[48:51], v6 offset:16384
    ds_read_b128 a[52:55], v7 offset:16384
    ds_read_b128 a[56:59], v8 offset:16384
    ds_read_b128 a[60:63], v9 offset:16384
    s_mov_b32 s60, 0
    s_waitcnt lgkmcnt(7)
    v_mfma_f32_32x32x16_bf16 v[48:63], a[32:35], a[0:3], 0
    s_waitcnt lgkmcnt(6)
    v_mfma_f32_32x32x16_bf16 v[48:63], a[36:39], a[4:7], v[48:63]
    s_waitcnt lgkmcnt(5)
    v_mfma_f32_32x32x16_bf16 v[48:63], a[40:43], a[8:11], v[48:63]
    s_waitcnt lgkmcnt(4)
    v_mfma_f32_32x32x16_bf16 v[48:63], a[44:47], a[12:15], v[48:63]
    s_waitcnt lgkmcnt(3)
    v_mfma_f32_32x32x16_bf16 v[48:63], a[48:51], a[16:19], v[48:63]
    s_waitcnt lgkmcnt(2)
    v_mfma_f32_32x32x16_bf16 v[48:63], a[52:55], a[20:23], v[48:63]
    s_waitcnt lgkmcnt(1)
    v_mfma_f32_32x32x16_bf16 v[48:63], a[56:59], a[24:27], v[48:63]
    s_waitcnt lgkmcnt(0)
    v_mfma_f32_32x32x16_bf16 v[48:63], a[60:63], a[28:31], v[48:63]
    ds_read_b128 a[32:35], v2 offset:32768
    ds_read_b128 a[36:39], v3 offset:32768
    ds_read_b128 a[40:43], v4 offset:32768
    ds_read_b128 a[44:47], v5 offset:32768
    ds_read_b128 a[48:51], v6 offset:32768
    ds_read_b128 a[52:55], v7 offset:32768
    ds_read_b128 a[56:59], v8 offset:32768
    ds_read_b128 a[60:63], v9 offset:32768
    s_nop 3
    v_max3_f32 v15, v48, v49, v50
    v_max3_f32 v18, v51, v52, v53
    v_max3_f32 v15, v15, v54, v55
    v_max3_f32 v18, v18, v56, v57
    v_max3_f32 v15, v15, v58, v59
    v_max3_f32 v18, v18, v60, v61
    v_max3_f32 v15, v15, v62, v63
    v_max_f32 v15, v15, v18
    v_mov_b32 v18, v15
    s_nop 1
    v_permlane32_swap_b32 v15, v18
    s_nop 1
    v_max_f32 v15, v15, v18
    v_mul_f32 v15, s66, v15
    v_mov_b32 v16, v15
    v_fma_f32 v48, v48, s66, -v16
    v_fma_f32 v49, v49, s66, -v16
    v_fma_f32 v50, v50, s66, -v16
    v_exp_f32 v48, v48
    v_fma_f32 v51, v51, s66, -v16
    v_exp_f32 v49, v49
    v_mov_b32 v17, v48
    v_exp_f32 v50, v50
    v_add_f32 v17, v17, v49
    v_cvt_pk_bf16_f32 v40, v48, v49
    v_exp_f32 v51, v51
    v_add_f32 v17, v17, v50
    s_nop 0
    v_add_f32 v17, v17, v51
    v_cvt_pk_bf16_f32 v41, v50, v51
    s_waitcnt lgkmcnt(0)
    v_add_u32 v10, 0x10000, v10
    v_add_u32 v11, 0x10000, v11
    v_add_u32 v12, 0x10000, v12
    v_add_u32 v13, 0x10000, v13
    s_barrier
    v_mfma_f32_32x32x16_bf16 v[64:79], a[32:35], a[0:3], 0
    ds_read_b64_tr_b16 a[64:65], v10 offset:49152
    ds_read_b64_tr_b16 a[66:67], v10 offset:51200
    v_fma_f32 v52, v52, s66, -v16
    v_fma_f32 v53, v53, s66, -v16
    v_fma_f32 v54, v54, s66, -v16
    v_exp_f32 v52, v52
    v_fma_f32 v55, v55, s66, -v16
    v_exp_f32 v53, v53
    v_mfma_f32_32x32x16_bf16 v[64:79], a[36:39], a[4:7], v[64:79]
    ds_read_b64_tr_b16 a[68:69], v11 offset:49152
    ds_read_b64_tr_b16 a[70:71], v11 offset:51200
    v_fma_f32 v56, v56, s66, -v16
    v_add_f32 v17, v17, v52
    v_exp_f32 v54, v54
    v_fma_f32 v57, v57, s66, -v16
    v_add_f32 v17, v17, v53
    v_cvt_pk_bf16_f32 v42, v52, v53
    v_mfma_f32_32x32x16_bf16 v[64:79], a[40:43], a[8:11], v[64:79]
    ds_read_b64_tr_b16 a[72:73], v12 offset:49152
    ds_read_b64_tr_b16 a[74:75], v12 offset:51200
    v_exp_f32 v55, v55
    v_fma_f32 v58, v58, s66, -v16
    v_add_f32 v17, v17, v54
    v_exp_f32 v56, v56
    v_fma_f32 v59, v59, s66, -v16
    v_add_f32 v17, v17, v55
    v_mfma_f32_32x32x16_bf16 v[64:79], a[44:47], a[12:15], v[64:79]
    ds_read_b64_tr_b16 a[76:77], v13 offset:49152
    ds_read_b64_tr_b16 a[78:79], v13 offset:51200
    v_cvt_pk_bf16_f32 v43, v54, v55
    v_exp_f32 v57, v57
    v_fma_f32 v60, v60, s66, -v16
    v_add_f32 v17, v17, v56
    v_exp_f32 v58, v58
    v_fma_f32 v61, v61, s66, -v16
    v_mfma_f32_32x32x16_bf16 v[64:79], a[48:51], a[16:19], v[64:79]
    ds_read_b64_tr_b16 a[80:81], v10 offset:53248
    ds_read_b64_tr_b16 a[82:83], v10 offset:55296
    v_add_f32 v17, v17, v57
    v_cvt_pk_bf16_f32 v44, v56, v57
    v_exp_f32 v59, v59
    v_fma_f32 v62, v62, s66, -v16
    v_add_f32 v17, v17, v58
    v_exp_f32 v60, v60
    v_mfma_f32_32x32x16_bf16 v[64:79], a[52:55], a[20:23], v[64:79]
    ds_read_b64_tr_b16 a[84:85], v11 offset:53248
    ds_read_b64_tr_b16 a[86:87], v11 offset:55296
    v_fma_f32 v63, v63, s66, -v16
    v_add_f32 v17, v17, v59
    v_cvt_pk_bf16_f32 v45, v58, v59
    v_exp_f32 v61, v61
    v_add_f32 v17, v17, v60
    v_exp_f32 v62, v62
    v_mfma_f32_32x32x16_bf16 v[64:79], a[56:59], a[24:27], v[64:79]
    ds_read_b64_tr_b16 a[88:89], v12 offset:53248
    ds_read_b64_tr_b16 a[90:91], v12 offset:55296
    v_add_f32 v17, v17, v61
    v_cvt_pk_bf16_f32 v46, v60, v61
    v_exp_f32 v63, v63
    v_add_f32 v17, v17, v62
    s_nop 0
    v_add_f32 v17, v17, v63
    v_mfma_f32_32x32x16_bf16 v[64:79], a[60:63], a[28:31], v[64:79]
    ds_read_b64_tr_b16 a[92:93], v13 offset:53248
    ds_read_b64_tr_b16 a[94:95], v13 offset:55296
    v_cvt_pk_bf16_f32 v47, v62, v63
    v_add_u32 v2, 0x10000, v2
    v_add_u32 v3, 0x10000, v3
    v_add_u32 v4, 0x10000, v4
    v_add_u32 v5, 0x10000, v5
    v_add_u32 v6, 0x10000, v6
    v_add_u32 v7, 0x10000, v7
    v_add_u32 v8, 0x10000, v8
    v_add_u32 v9, 0x10000, v9
    s_waitcnt lgkmcnt(0)
    v_mfma_f32_32x32x16_bf16 v[80:95], a[64:67], v[40:43], 0
    ds_read_b128 a[32:35], v2 offset:0
    ds_read_b128 a[36:39], v3 offset:0
    ds_read_b128 a[40:43], v4 offset:0
    v_mfma_f32_32x32x16_bf16 v[96:111], a[68:71], v[40:43], 0
    ds_read_b128 a[44:47], v5 offset:0
    ds_read_b128 a[48:51], v6 offset:0
    ds_read_b128 a[52:55], v7 offset:0
    v_mfma_f32_32x32x16_bf16 v[112:127], a[72:75], v[40:43], 0
    ds_read_b128 a[56:59], v8 offset:0
    ds_read_b128 a[60:63], v9 offset:0
    v_max3_f32 v15, v64, v65, v66
    v_max3_f32 v18, v67, v68, v69
    v_max3_f32 v15, v15, v70, v71
    v_max3_f32 v18, v18, v72, v73
    v_max3_f32 v15, v15, v74, v75
    v_mfma_f32_32x32x16_bf16 v[128:143], a[76:79], v[40:43], 0
    v_max3_f32 v18, v18, v76, v77
    v_max3_f32 v15, v15, v78, v79
    v_max_f32 v15, v15, v18
    v_mov_b32 v18, v15
    s_nop 1
    v_mfma_f32_32x32x16_bf16 v[80:95], a[80:83], v[44:47], v[80:95]
    v_permlane32_swap_b32 v15, v18
    s_nop 1
    v_max_f32 v15, v15, v18
    v_mul_f32 v15, s66, v15
    v_mfma_f32_32x32x16_bf16 v[96:111], a[84:87], v[44:47], v[96:111]
    v_sub_f32 v18, v15, v16
    v_cmp_lt_f32 vcc, s67, v18
    s_cbranch_vccz L_nors_c6
    v_max_f32 v18, v15, v16
    v_sub_f32 v19, v16, v18
    v_exp_f32 v19, v19
    v_mov_b32 v16, v18
    s_mov_b32 s60, 1
    v_mul_f32 v17, v17, v19
L_nors_c6:
    v_fma_f32 v64, v64, s66, -v16
    v_fma_f32 v65, v65, s66, -v16
    v_fma_f32 v66, v66, s66, -v16
    v_exp_f32 v64, v64
    v_fma_f32 v67, v67, s66, -v16
    v_mfma_f32_32x32x16_bf16 v[112:127], a[88:91], v[44:47], v[112:127]
    v_exp_f32 v65, v65
    v_add_f32 v17, v17, v64
    v_exp_f32 v66, v66
    v_add_f32 v17, v17, v65
    v_cvt_pk_bf16_f32 v144, v64, v65
    v_mfma_f32_32x32x16_bf16 v[128:143], a[92:95], v[44:47], v[128:143]
    v_exp_f32 v67, v67
    v_add_f32 v17, v17, v66
    s_nop 0
    v_add_f32 v17, v17, v67
    v_cvt_pk_bf16_f32 v145, v66, v67
    s_cmp_eq_u32 s60, 0
    s_cbranch_scc1 L_nopend_c7
    s_nop 7
    s_nop 7
    v_mul_f32 v80, v80, v19
    v_mul_f32 v81, v81, v19
    v_mul_f32 v82, v82, v19
    v_mul_f32 v83, v83, v19
    v_mul_f32 v84, v84, v19
    v_mul_f32 v85, v85, v19
    v_mul_f32 v86, v86, v19
    v_mul_f32 v87, v87, v19
    v_mul_f32 v88, v88, v19
    v_mul_f32 v89, v89, v19
    v_mul_f32 v90, v90, v19
    v_mul_f32 v91, v91, v19
    v_mul_f32 v92, v92, v19
    v_mul_f32 v93, v93, v19
    v_mul_f32 v94, v94, v19
    v_mul_f32 v95, v95, v19
    v_mul_f32 v96, v96, v19
    v_mul_f32 v97, v97, v19
    v_mul_f32 v98, v98, v19
    v_mul_f32 v99, v99, v19
    v_mul_f32 v100, v100, v19
    v_mul_f32 v101, v101, v19
    v_mul_f32 v102, v102, v19
    v_mul_f32 v103, v103, v19
    v_mul_f32 v104, v104, v19
    v_mul_f32 v105, v105, v19
    v_mul_f32 v106, v106, v19
    v_mul_f32 v107, v107, v19
    v_mul_f32 v108, v108, v19
    v_mul_f32 v109, v109, v19
    v_mul_f32 v110, v110, v19
    v_mul_f32 v111, v111, v19
    v_mul_f32 v112, v112, v19
    v_mul_f32 v113, v113, v19
    v_mul_f32 v114, v114, v19
    v_mul_f32 v115, v115, v19
    v_mul_f32 v116, v116, v19
    v_mul_f32 v117, v117, v19
    v_mul_f32 v118, v118, v19
    v_mul_f32 v119, v119, v19
    v_mul_f32 v120, v120, v19
    v_mul_f32 v121, v121, v19
    v_mul_f32 v122, v122, v19
    v_mul_f32 v123, v123, v19
    v_mul_f32 v124, v124, v19
    v_mul_f32 v125, v125, v19
    v_mul_f32 v126, v126, v19
    v_mul_f32 v127, v127, v19
    v_mul_f32 v128, v128, v19
    v_mul_f32 v129, v129, v19
    v_mul_f32 v130, v130, v19
    v_mul_f32 v131, v131, v19
    v_mul_f32 v132, v132, v19
    v_mul_f32 v133, v133, v19
    v_mul_f32 v134, v134, v19
    v_mul_f32 v135, v135, v19
    v_mul_f32 v136, v136, v19
    v_mul_f32 v137, v137, v19
    v_mul_f32 v138, v138, v19
    v_mul_f32 v139, v139, v19
    v_mul_f32 v140, v140, v19
    v_mul_f32 v141, v141, v19
    v_mul_f32 v142, v142, v19
    v_mul_f32 v143, v143, v19
    s_mov_b32 s60, 0
    s_nop 1
L_nopend_c7:
    s_waitcnt lgkmcnt(0)
    v_add_u32 v10, 0x10000, v10
    v_add_u32 v11, 0x10000, v11
    v_add_u32 v12, 0x10000, v12
    v_add_u32 v13, 0x10000, v13
    s_barrier
    v_mfma_f32_32x32x16_bf16 v[48:63], a[32:35], a[0:3], 0
    ds_read_b64_tr_b16 a[64:65], v10 offset:16384
    ds_read_b64_tr_b16 a[66:67], v10 offset:18432
    v_fma_f32 v68, v68, s66, -v16
    v_fma_f32 v69, v69, s66, -v16
    v_fma_f32 v70, v70, s66, -v16
    v_exp_f32 v68, v68
    v_fma_f32 v71, v71, s66, -v16
    v_exp_f32 v69, v69
    v_mfma_f32_32x32x16_bf16 v[48:63], a[36:39], a[4:7], v[48:63]
    ds_read_b64_tr_b16 a[68:69], v11 offset:16384
    ds_read_b64_tr_b16 a[70:71], v11 offset:18432
    v_fma_f32 v72, v72, s66, -v16
    v_add_f32 v17, v17, v68
    v_exp_f32 v70, v70
    v_fma_f32 v73, v73, s66, -v16
    v_add_f32 v17, v17, v69
    v_cvt_pk_bf16_f32 v146, v68, v69
    v_mfma_f32_32x32x16_bf16 v[48:63], a[40:43], a[8:11], v[48:63]
    ds_read_b64_tr_b16 a[72:73], v12 offset:16384
    ds_read_b64_tr_b16 a[74:75], v12 offset:18432
    v_exp_f32 v71, v71
    v_fma_f32 v74, v74, s66, -v16
    v_add_f32 v17, v17, v70
    v_exp_f32 v72, v72
    v_fma_f32 v75, v75, s66, -v16
    v_add_f32 v17, v17, v71
    v_mfma_f32_32x32x16_bf16 v[48:63], a[44:47], a[12:15], v[48:63]
    ds_read_b64_tr_b16 a[76:77], v13 offset:16384
    ds_read_b64_tr_b16 a[78:79], v13 offset:18432
    v_cvt_pk_bf16_f32 v147, v70, v71
    v_exp_f32 v73, v73
    v_fma_f32 v76, v76, s66, -v16
    v_add_f32 v17, v17, v72
    v_exp_f32 v74, v74
    v_fma_f32 v77, v77, s66, -v16
    v_mfma_f32_32x32x16_bf16 v[48:63], a[48:51], a[16:19], v[48:63]
    ds_read_b64_tr_b16 a[80:81], v10 offset:20480
    ds_read_b64_tr_b16 a[82:83], v10 offset:22528
    v_add_f32 v17, v17, v73
    v_cvt_pk_bf16_f32 v148, v72, v73
    v_exp_f32 v75, v75
    v_fma_f32 v78, v78, s66, -v16
    v_add_f32 v17, v17, v74
    v_exp_f32 v76, v76
    v_mfma_f32_32x32x16_bf16 v[48:63], a[52:55], a[20:23], v[48:63]
    ds_read_b64_tr_b16 a[84:85], v11 offset:20480
    ds_read_b64_tr_b16 a[86:87], v11 offset:22528
    v_fma_f32 v79, v79, s66, -v16
    v_add_f32 v17, v17, v75
    v_cvt_pk_bf16_f32 v149, v74, v75
    v_exp_f32 v77, v77
    v_add_f32 v17, v17, v76
    v_exp_f32 v78, v78
    v_mfma_f32_32x32x16_bf16 v[48:63], a[56:59], a[24:27], v[48:63]
    ds_read_b64_tr_b16 a[88:89], v12 offset:20480
    ds_read_b64_tr_b16 a[90:91], v12 offset:22528
    v_add_f32 v17, v17, v77
    v_cvt_pk_bf16_f32 v150, v76, v77
    v_exp_f32 v79, v79
    v_add_f32 v17, v17, v78
    s_nop 0
    v_add_f32 v17, v17, v79
    v_mfma_f32_32x32x16_bf16 v[48:63], a[60:63], a[28:31], v[48:63]
    ds_read_b64_tr_b16 a[92:93], v13 offset:20480
    ds_read_b64_tr_b16 a[94:95], v13 offset:22528
    v_cvt_pk_bf16_f32 v151, v78, v79
    v_subrev_u32 v2, 0x20000, v2
    v_subrev_u32 v3, 0x20000, v3
    v_subrev_u32 v4, 0x20000, v4
    v_subrev_u32 v5, 0x20000, v5
    v_subrev_u32 v6, 0x20000, v6
    v_subrev_u32 v7, 0x20000, v7
    v_subrev_u32 v8, 0x20000, v8
    v_subrev_u32 v9, 0x20000, v9
    s_waitcnt lgkmcnt(0)
    v_mfma_f32_32x32x16_bf16 v[80:95], a[64:67], v[144:147], v[80:95]
    ds_read_b128 a[32:35], v2 offset:0
    ds_read_b128 a[36:39], v3 offset:0
    ds_read_b128 a[40:43], v4 offset:0
    v_mfma_f32_32x32x16_bf16 v[96:111], a[68:71], v[144:147], v[96:111]
    ds_read_b128 a[44:47], v5 offset:0
    ds_read_b128 a[48:51], v6 offset:0
    ds_read_b128 a[52:55], v7 offset:0
    v_mfma_f32_32x32x16_bf16 v[112:127], a[72:75], v[144:147], v[112:127]
    ds_read_b128 a[56:59], v8 offset:0
    ds_read_b128 a[60:63], v9 offset:0
    v_max3_f32 v15, v48, v49, v50
    v_max3_f32 v18, v51, v52, v53
    v_max3_f32 v15, v15, v54, v55
    v_max3_f32 v18, v18, v56, v57
    v_max3_f32 v15, v15, v58, v59
    v_mfma_f32_32x32x16_bf16 v[128:143], a[76:79], v[144:147], v[128:143]
    v_max3_f32 v18, v18, v60, v61
    v_max3_f32 v15, v15, v62, v63
    v_max_f32 v15, v15, v18
    v_mov_b32 v18, v15
    s_nop 1
    v_mfma_f32_32x32x16_bf16 v[80:95], a[80:83], v[148:151], v[80:95]
    v_permlane32_swap_b32 v15, v18
    s_nop 1
    v_max_f32 v15, v15, v18
    v_mul_f32 v15, s66, v15
    v_mfma_f32_32x32x16_bf16 v[96:111], a[84:87], v[148:151], v[96:111]
    v_sub_f32 v18, v15, v16
    v_cmp_lt_f32 vcc, s67, v18
    s_cbranch_vccz L_nors_c8
    v_max_f32 v18, v15, v16
    v_sub_f32 v19, v16, v18
    v_exp_f32 v19, v19
    v_mov_b32 v16, v18
    s_mov_b32 s60, 1
    v_mul_f32 v17, v17, v19
L_nors_c8:
    v_fma_f32 v48, v48, s66, -v16
    v_fma_f32 v49, v49, s66, -v16
    v_fma_f32 v50, v50, s66, -v16
    v_exp_f32 v48, v48
    v_fma_f32 v51, v51, s66, -v16
    v_mfma_f32_32x32x16_bf16 v[112:127], a[88:91], v[148:151], v[112:127]
    v_exp_f32 v49, v49
    v_add_f32 v17, v17, v48
    v_exp_f32 v50, v50
    v_add_f32 v17, v17, v49
    v_cvt_pk_bf16_f32 v40, v48, v49
    v_mfma_f32_32x32x16_bf16 v[128:143], a[92:95], v[148:151], v[128:143]
    v_exp_f32 v51, v51
    v_add_f32 v17, v17, v50
    s_nop 0
    v_add_f32 v17, v17, v51
    v_cvt_pk_bf16_f32 v41, v50, v51
    s_cmp_eq_u32 s60, 0
    s_cbranch_scc1 L_nopend_c9
    s_nop 7
    s_nop 7
    v_mul_f32 v80, v80, v19
    v_mul_f32 v81, v81, v19
    v_mul_f32 v82, v82, v19
    v_mul_f32 v83, v83, v19
    v_mul_f32 v84, v84, v19
    v_mul_f32 v85, v85, v19
    v_mul_f32 v86, v86, v19
    v_mul_f32 v87, v87, v19
    v_mul_f32 v88, v88, v19
    v_mul_f32 v89, v89, v19
    v_mul_f32 v90, v90, v19
    v_mul_f32 v91, v91, v19
    v_mul_f32 v92, v92, v19
    v_mul_f32 v93, v93, v19
    v_mul_f32 v94, v94, v19
    v_mul_f32 v95, v95, v19
    v_mul_f32 v96, v96, v19
    v_mul_f32 v97, v97, v19
    v_mul_f32 v98, v98, v19
    v_mul_f32 v99, v99, v19
    v_mul_f32 v100, v100, v19
    v_mul_f32 v101, v101, v19
    v_mul_f32 v102, v102, v19
    v_mul_f32 v103, v103, v19
    v_mul_f32 v104, v104, v19
    v_mul_f32 v105, v105, v19
    v_mul_f32 v106, v106, v19
    v_mul_f32 v107, v107, v19
    v_mul_f32 v108, v108, v19
    v_mul_f32 v109, v109, v19
    v_mul_f32 v110, v110, v19
    v_mul_f32 v111, v111, v19
    v_mul_f32 v112, v112, v19
    v_mul_f32 v113, v113, v19
    v_mul_f32 v114, v114, v19
    v_mul_f32 v115, v115, v19
    v_mul_f32 v116, v116, v19
    v_mul_f32 v117, v117, v19
    v_mul_f32 v118, v118, v19
    v_mul_f32 v119, v119, v19
    v_mul_f32 v120, v120, v19
    v_mul_f32 v121, v121, v19
    v_mul_f32 v122, v122, v19
    v_mul_f32 v123, v123, v19
    v_mul_f32 v124, v124, v19
    v_mul_f32 v125, v125, v19
    v_mul_f32 v126, v126, v19
    v_mul_f32 v127, v127, v19
    v_mul_f32 v128, v128, v19
    v_mul_f32 v129, v129, v19
    v_mul_f32 v130, v130, v19
    v_mul_f32 v131, v131, v19
    v_mul_f32 v132, v132, v19
    v_mul_f32 v133, v133, v19
    v_mul_f32 v134, v134, v19
    v_mul_f32 v135, v135, v19
    v_mul_f32 v136, v136, v19
    v_mul_f32 v137, v137, v19
    v_mul_f32 v138, v138, v19
    v_mul_f32 v139, v139, v19
    v_mul_f32 v140, v140, v19
    v_mul_f32 v141, v141, v19
    v_mul_f32 v142, v142, v19
    v_mul_f32 v143, v143, v19
    s_mov_b32 s60, 0
    s_nop 1
L_nopend_c9:
    s_waitcnt lgkmcnt(0)
    v_subrev_u32 v10, 0x20000, v10
    v_subrev_u32 v11, 0x20000, v11
    v_subrev_u32 v12, 0x20000, v12
    v_subrev_u32 v13, 0x20000, v13
    s_barrier
    v_mfma_f32_32x32x16_bf16 v[64:79], a[32:35], a[0:3], 0
    ds_read_b64_tr_b16 a[64:65], v10 offset:16384
    ds_read_b64_tr_b16 a[66:67], v10 offset:18432
    v_fma_f32 v52, v52, s66, -v16
    v_fma_f32 v53, v53, s66, -v16
    v_fma_f32 v54, v54, s66, -v16
    v_exp_f32 v52, v52
    v_fma_f32 v55, v55, s66, -v16
    v_exp_f32 v53, v53
    v_mfma_f32_32x32x16_bf16 v[64:79], a[36:39], a[4:7], v[64:79]
    ds_read_b64_tr_b16 a[68:69], v11 offset:16384
    ds_read_b64_tr_b16 a[70:71], v11 offset:18432
    v_fma_f32 v56, v56, s66, -v16
    v_add_f32 v17, v17, v52
    v_exp_f32 v54, v54
    v_fma_f32 v57, v57, s66, -v16
    v_add_f32 v17, v17, v53
    v_cvt_pk_bf16_f32 v42, v52, v53
    v_mfma_f32_32x32x16_bf16 v[64:79], a[40:43], a[8:11], v[64:79]
    ds_read_b64_tr_b16 a[72:73], v12 offset:16384
    ds_read_b64_tr_b16 a[74:75], v12 offset:18432
    v_exp_f32 v55, v55
    v_fma_f32 v58, v58, s66, -v16
    v_add_f32 v17, v17, v54
    v_exp_f32 v56, v56
    v_fma_f32 v59, v59, s66, -v16
    v_add_f32 v17, v17, v55
    v_mfma_f32_32x32x16_bf16 v[64:79], a[44:47], a[12:15], v[64:79]
    ds_read_b64_tr_b16 a[76:77], v13 offset:16384
    ds_read_b64_tr_b16 a[78:79], v13 offset:18432
    v_cvt_pk_bf16_f32 v43, v54, v55
    v_exp_f32 v57, v57
    v_fma_f32 v60, v60, s66, -v16
    v_add_f32 v17, v17, v56
    v_exp_f32 v58, v58
    v_fma_f32 v61, v61, s66, -v16
    v_mfma_f32_32x32x16_bf16 v[64:79], a[48:51], a[16:19], v[64:79]
    ds_read_b64_tr_b16 a[80:81], v10 offset:20480
    ds_read_b64_tr_b16 a[82:83], v10 offset:22528
    v_add_f32 v17, v17, v57
    v_cvt_pk_bf16_f32 v44, v56, v57
    v_exp_f32 v59, v59
    v_fma_f32 v62, v62, s66, -v16
    v_add_f32 v17, v17, v58
    v_exp_f32 v60, v60
    v_mfma_f32_32x32x16_bf16 v[64:79], a[52:55], a[20:23], v[64:79]
    ds_read_b64_tr_b16 a[84:85], v11 offset:20480
    ds_read_b64_tr_b16 a[86:87], v11 offset:22528
    v_fma_f32 v63, v63, s66, -v16
    v_add_f32 v17, v17, v59
    v_cvt_pk_bf16_f32 v45, v58, v59
    v_exp_f32 v61, v61
    v_add_f32 v17, v17, v60
    v_exp_f32 v62, v62
    v_mfma_f32_32x32x16_bf16 v[64:79], a[56:59], a[24:27], v[64:79]
    ds_read_b64_tr_b16 a[88:89], v12 offset:20480
    ds_read_b64_tr_b16 a[90:91], v12 offset:22528
    v_add_f32 v17, v17, v61
    v_cvt_pk_bf16_f32 v46, v60, v61
    v_exp_f32 v63, v63
    v_add_f32 v17, v17, v62
    s_nop 0
    v_add_f32 v17, v17, v63
    v_mfma_f32_32x32x16_bf16 v[64:79], a[60:63], a[28:31], v[64:79]
    ds_read_b64_tr_b16 a[92:93], v13 offset:20480
    ds_read_b64_tr_b16 a[94:95], v13 offset:22528
    v_cvt_pk_bf16_f32 v47, v62, v63
    s_waitcnt lgkmcnt(0)
    v_mfma_f32_32x32x16_bf16 v[80:95], a[64:67], v[40:43], v[80:95]
    ds_read_b128 a[32:35], v2 offset:32768
    ds_read_b128 a[36:39], v3 offset:32768
    ds_read_b128 a[40:43], v4 offset:32768
    v_mfma_f32_32x32x16_bf16 v[96:111], a[68:71], v[40:43], v[96:111]
    ds_read_b128 a[44:47], v5 offset:32768
    ds_read_b128 a[48:51], v6 offset:32768
    ds_read_b128 a[52:55], v7 offset:32768
    v_mfma_f32_32x32x16_bf16 v[112:127], a[72:75], v[40:43], v[112:127]
    ds_read_b128 a[56:59], v8 offset:32768
    ds_read_b128 a[60:63], v9 offset:32768
    v_max3_f32 v15, v64, v65, v66
    v_max3_f32 v18, v67, v68, v69
    v_max3_f32 v15, v15, v70, v71
    v_max3_f32 v18, v18, v72, v73
    v_max3_f32 v15, v15, v74, v75
    v_mfma_f32_32x32x16_bf16 v[128:143], a[76:79], v[40:43], v[128:143]
    v_max3_f32 v18, v18, v76, v77
    v_max3_f32 v15, v15, v78, v79
    v_max_f32 v15, v15, v18
    v_mov_b32 v18, v15
    s_nop 1
    v_mfma_f32_32x32x16_bf16 v[80:95], a[80:83], v[44:47], v[80:95]
    v_permlane32_swap_b32 v15, v18
    s_nop 1
    v_max_f32 v15, v15, v18
    v_mul_f32 v15, s66, v15
    v_mfma_f32_32x32x16_bf16 v[96:111], a[84:87], v[44:47], v[96:111]
    v_sub_f32 v18, v15, v16
    v_cmp_lt_f32 vcc, s67, v18
    s_cbranch_vccz L_nors_c10
    v_max_f32 v18, v15, v16
    v_sub_f32 v19, v16, v18
    v_exp_f32 v19, v19
    v_mov_b32 v16, v18
    s_mov_b32 s60, 1
    v_mul_f32 v17, v17, v19
L_nors_c10:
    v_fma_f32 v64, v64, s66, -v16
    v_fma_f32 v65, v65, s66, -v16
    v_fma_f32 v66, v66, s66, -v16
    v_exp_f32 v64, v64
    v_fma_f32 v67, v67, s66, -v16
    v_mfma_f32_32x32x16_bf16 v[112:127], a[88:91], v[44:47], v[112:127]
    v_exp_f32 v65, v65
    v_add_f32 v17, v17, v64
    v_exp_f32 v66, v66
    v_add_f32 v17, v17, v65
    v_cvt_pk_bf16_f32 v144, v64, v65
    v_mfma_f32_32x32x16_bf16 v[128:143], a[92:95], v[44:47], v[128:143]
    v_exp_f32 v67, v67
    v_add_f32 v17, v17, v66
    s_nop 0
    v_add_f32 v17, v17, v67
    v_cvt_pk_bf16_f32 v145, v66, v67
    s_cmp_eq_u32 s60, 0
    s_cbranch_scc1 L_nopend_c11
    s_nop 7
    s_nop 7
    v_mul_f32 v80, v80, v19
    v_mul_f32 v81, v81, v19
    v_mul_f32 v82, v82, v19
    v_mul_f32 v83, v83, v19
    v_mul_f32 v84, v84, v19
    v_mul_f32 v85, v85, v19
    v_mul_f32 v86, v86, v19
    v_mul_f32 v87, v87, v19
    v_mul_f32 v88, v88, v19
    v_mul_f32 v89, v89, v19
    v_mul_f32 v90, v90, v19
    v_mul_f32 v91, v91, v19
    v_mul_f32 v92, v92, v19
    v_mul_f32 v93, v93, v19
    v_mul_f32 v94, v94, v19
    v_mul_f32 v95, v95, v19
    v_mul_f32 v96, v96, v19
    v_mul_f32 v97, v97, v19
    v_mul_f32 v98, v98, v19
    v_mul_f32 v99, v99, v19
    v_mul_f32 v100, v100, v19
    v_mul_f32 v101, v101, v19
    v_mul_f32 v102, v102, v19
    v_mul_f32 v103, v103, v19
    v_mul_f32 v104, v104, v19
    v_mul_f32 v105, v105, v19
    v_mul_f32 v106, v106, v19
    v_mul_f32 v107, v107, v19
    v_mul_f32 v108, v108, v19
    v_mul_f32 v109, v109, v19
    v_mul_f32 v110, v110, v19
    v_mul_f32 v111, v111, v19
    v_mul_f32 v112, v112, v19
    v_mul_f32 v113, v113, v19
    v_mul_f32 v114, v114, v19
    v_mul_f32 v115, v115, v19
    v_mul_f32 v116, v116, v19
    v_mul_f32 v117, v117, v19
    v_mul_f32 v118, v118, v19
    v_mul_f32 v119, v119, v19
    v_mul_f32 v120, v120, v19
    v_mul_f32 v121, v121, v19
    v_mul_f32 v122, v122, v19
    v_mul_f32 v123, v123, v19
    v_mul_f32 v124, v124, v19
    v_mul_f32 v125, v125, v19
    v_mul_f32 v126, v126, v19
    v_mul_f32 v127, v127, v19
    v_mul_f32 v128, v128, v19
    v_mul_f32 v129, v129, v19
    v_mul_f32 v130, v130, v19
    v_mul_f32 v131, v131, v19
    v_mul_f32 v132, v132, v19
    v_mul_f32 v133, v133, v19
    v_mul_f32 v134, v134, v19
    v_mul_f32 v135, v135, v19
    v_mul_f32 v136, v136, v19
    v_mul_f32 v137, v137, v19
    v_mul_f32 v138, v138, v19
    v_mul_f32 v139, v139, v19
    v_mul_f32 v140, v140, v19
    v_mul_f32 v141, v141, v19
    v_mul_f32 v142, v142, v19
    v_mul_f32 v143, v143, v19
    s_mov_b32 s60, 0
    s_nop 1
L_nopend_c11:
    s_waitcnt lgkmcnt(0)
    s_barrier
    v_mfma_f32_32x32x16_bf16 v[48:63], a[32:35], a[0:3], 0
    ds_read_b64_tr_b16 a[64:65], v10 offset:49152
    ds_read_b64_tr_b16 a[66:67], v10 offset:51200
    v_fma_f32 v68, v68, s66, -v16
    v_fma_f32 v69, v69, s66, -v16
    v_fma_f32 v70, v70, s66, -v16
    v_exp_f32 v68, v68
    v_fma_f32 v71, v71, s66, -v16
    v_exp_f32 v69, v69
    v_mfma_f32_32x32x16_bf16 v[48:63], a[36:39], a[4:7], v[48:63]
    ds_read_b64_tr_b16 a[68:69], v11 offset:49152
    ds_read_b64_tr_b16 a[70:71], v11 offset:51200
    v_fma_f32 v72, v72, s66, -v16
    v_add_f32 v17, v17, v68
    v_exp_f32 v70, v70
    v_fma_f32 v73, v73, s66, -v16
    v_add_f32 v17, v17, v69
    v_cvt_pk_bf16_f32 v146, v68, v69
    v_mfma_f32_32x32x16_bf16 v[48:63], a[40:43], a[8:11], v[48:63]
    ds_read_b64_tr_b16 a[72:73], v12 offset:49152
    ds_read_b64_tr_b16 a[74:75], v12 offset:51200
    v_exp_f32 v71, v71
    v_fma_f32 v74, v74, s66, -v16
    v_add_f32 v17, v17, v70
    v_exp_f32 v72, v72
    v_fma_f32 v75, v75, s66, -v16
    v_add_f32 v17, v17, v71
    v_mfma_f32_32x32x16_bf16 v[48:63], a[44:47], a[12:15], v[48:63]
    ds_read_b64_tr_b16 a[76:77], v13 offset:49152
    ds_read_b64_tr_b16 a[78:79], v13 offset:51200
    v_cvt_pk_bf16_f32 v147, v70, v71
    v_exp_f32 v73, v73
    v_fma_f32 v76, v76, s66, -v16
    v_add_f32 v17, v17, v72
    v_exp_f32 v74, v74
    v_fma_f32 v77, v77, s66, -v16
    v_mfma_f32_32x32x16_bf16 v[48:63], a[48:51], a[16:19], v[48:63]
    ds_read_b64_tr_b16 a[80:81], v10 offset:53248
    ds_read_b64_tr_b16 a[82:83], v10 offset:55296
    v_add_f32 v17, v17, v73
    v_cvt_pk_bf16_f32 v148, v72, v73
    v_exp_f32 v75, v75
    v_fma_f32 v78, v78, s66, -v16
    v_add_f32 v17, v17, v74
    v_exp_f32 v76, v76
    v_mfma_f32_32x32x16_bf16 v[48:63], a[52:55], a[20:23], v[48:63]
    ds_read_b64_tr_b16 a[84:85], v11 offset:53248
    ds_read_b64_tr_b16 a[86:87], v11 offset:55296
    v_fma_f32 v79, v79, s66, -v16
    v_add_f32 v17, v17, v75
    v_cvt_pk_bf16_f32 v149, v74, v75
    v_exp_f32 v77, v77
    v_add_f32 v17, v17, v76
    v_exp_f32 v78, v78
    v_mfma_f32_32x32x16_bf16 v[48:63], a[56:59], a[24:27], v[48:63]
    ds_read_b64_tr_b16 a[88:89], v12 offset:53248
    ds_read_b64_tr_b16 a[90:91], v12 offset:55296
    v_add_f32 v17, v17, v77
    v_cvt_pk_bf16_f32 v150, v76, v77
    v_exp_f32 v79, v79
    v_add_f32 v17, v17, v78
    s_nop 0
    v_add_f32 v17, v17, v79
    v_mfma_f32_32x32x16_bf16 v[48:63], a[60:63], a[28:31], v[48:63]
    ds_read_b64_tr_b16 a[92:93], v13 offset:53248
    ds_read_b64_tr_b16 a[94:95], v13 offset:55296
    v_cvt_pk_bf16_f32 v151, v78, v79
    v_add_u32 v2, 0x10000, v2
    v_add_u32 v3, 0x10000, v3
    v_add_u32 v4, 0x10000, v4
    v_add_u32 v5, 0x10000, v5
    v_add_u32 v6, 0x10000, v6
    v_add_u32 v7, 0x10000, v7
    v_add_u32 v8, 0x10000, v8
    v_add_u32 v9, 0x10000, v9
    s_waitcnt lgkmcnt(0)
    v_mfma_f32_32x32x16_bf16 v[80:95], a[64:67], v[144:147], v[80:95]
    ds_read_b128 a[32:35], v2 offset:0
    ds_read_b128 a[36:39], v3 offset:0
    ds_read_b128 a[40:43], v4 offset:0
    v_mfma_f32_32x32x16_bf16 v[96:111], a[68:71], v[144:147], v[96:111]
    ds_read_b128 a[44:47], v5 offset:0
    ds_read_b128 a[48:51], v6 offset:0
    ds_read_b128 a[52:55], v7 offset:0
    v_mfma_f32_32x32x16_bf16 v[112:127], a[72:75], v[144:147], v[112:127]
    ds_read_b128 a[56:59], v8 offset:0
    ds_read_b128 a[60:63], v9 offset:0
    v_max3_f32 v15, v48, v49, v50
    v_max3_f32 v18, v51, v52, v53
    v_max3_f32 v15, v15, v54, v55
    v_max3_f32 v18, v18, v56, v57
    v_max3_f32 v15, v15, v58, v59
    v_mfma_f32_32x32x16_bf16 v[128:143], a[76:79], v[144:147], v[128:143]
    v_max3_f32 v18, v18, v60, v61
    v_max3_f32 v15, v15, v62, v63
    v_max_f32 v15, v15, v18
    v_mov_b32 v18, v15
    s_nop 1
    v_mfma_f32_32x32x16_bf16 v[80:95], a[80:83], v[148:151], v[80:95]
    v_permlane32_swap_b32 v15, v18
    s_nop 1
    v_max_f32 v15, v15, v18
    v_mul_f32 v15, s66, v15
    v_mfma_f32_32x32x16_bf16 v[96:111], a[84:87], v[148:151], v[96:111]
    v_sub_f32 v18, v15, v16
    v_cmp_lt_f32 vcc, s67, v18
    s_cbranch_vccz L_nors_c12
    v_max_f32 v18, v15, v16
    v_sub_f32 v19, v16, v18
    v_exp_f32 v19, v19
    v_mov_b32 v16, v18
    s_mov_b32 s60, 1
    v_mul_f32 v17, v17, v19
L_nors_c12:
    v_fma_f32 v48, v48, s66, -v16
    v_fma_f32 v49, v49, s66, -v16
    v_fma_f32 v50, v50, s66, -v16
    v_exp_f32 v48, v48
    v_fma_f32 v51, v51, s66, -v16
    v_mfma_f32_32x32x16_bf16 v[112:127], a[88:91], v[148:151], v[112:127]
    v_exp_f32 v49, v49
    v_add_f32 v17, v17, v48
    v_exp_f32 v50, v50
    v_add_f32 v17, v17, v49
    v_cvt_pk_bf16_f32 v40, v48, v49
    v_mfma_f32_32x32x16_bf16 v[128:143], a[92:95], v[148:151], v[128:143]
    v_exp_f32 v51, v51
    v_add_f32 v17, v17, v50
    s_nop 0
    v_add_f32 v17, v17, v51
    v_cvt_pk_bf16_f32 v41, v50, v51
    s_cmp_eq_u32 s60, 0
    s_cbranch_scc1 L_nopend_c13
    s_nop 7
    s_nop 7
    v_mul_f32 v80, v80, v19
    v_mul_f32 v81, v81, v19
    v_mul_f32 v82, v82, v19
    v_mul_f32 v83, v83, v19
    v_mul_f32 v84, v84, v19
    v_mul_f32 v85, v85, v19
    v_mul_f32 v86, v86, v19
    v_mul_f32 v87, v87, v19
    v_mul_f32 v88, v88, v19
    v_mul_f32 v89, v89, v19
    v_mul_f32 v90, v90, v19
    v_mul_f32 v91, v91, v19
    v_mul_f32 v92, v92, v19
    v_mul_f32 v93, v93, v19
    v_mul_f32 v94, v94, v19
    v_mul_f32 v95, v95, v19
    v_mul_f32 v96, v96, v19
    v_mul_f32 v97, v97, v19
    v_mul_f32 v98, v98, v19
    v_mul_f32 v99, v99, v19
    v_mul_f32 v100, v100, v19
    v_mul_f32 v101, v101, v19
    v_mul_f32 v102, v102, v19
    v_mul_f32 v103, v103, v19
    v_mul_f32 v104, v104, v19
    v_mul_f32 v105, v105, v19
    v_mul_f32 v106, v106, v19
    v_mul_f32 v107, v107, v19
    v_mul_f32 v108, v108, v19
    v_mul_f32 v109, v109, v19
    v_mul_f32 v110, v110, v19
    v_mul_f32 v111, v111, v19
    v_mul_f32 v112, v112, v19
    v_mul_f32 v113, v113, v19
    v_mul_f32 v114, v114, v19
    v_mul_f32 v115, v115, v19
    v_mul_f32 v116, v116, v19
    v_mul_f32 v117, v117, v19
    v_mul_f32 v118, v118, v19
    v_mul_f32 v119, v119, v19
    v_mul_f32 v120, v120, v19
    v_mul_f32 v121, v121, v19
    v_mul_f32 v122, v122, v19
    v_mul_f32 v123, v123, v19
    v_mul_f32 v124, v124, v19
    v_mul_f32 v125, v125, v19
    v_mul_f32 v126, v126, v19
    v_mul_f32 v127, v127, v19
    v_mul_f32 v128, v128, v19
    v_mul_f32 v129, v129, v19
    v_mul_f32 v130, v130, v19
    v_mul_f32 v131, v131, v19
    v_mul_f32 v132, v132, v19
    v_mul_f32 v133, v133, v19
    v_mul_f32 v134, v134, v19
    v_mul_f32 v135, v135, v19
    v_mul_f32 v136, v136, v19
    v_mul_f32 v137, v137, v19
    v_mul_f32 v138, v138, v19
    v_mul_f32 v139, v139, v19
    v_mul_f32 v140, v140, v19
    v_mul_f32 v141, v141, v19
    v_mul_f32 v142, v142, v19
    v_mul_f32 v143, v143, v19
    s_mov_b32 s60, 0
    s_nop 1
L_nopend_c13:
    s_waitcnt lgkmcnt(0)
    v_add_u32 v10, 0x10000, v10
    v_add_u32 v11, 0x10000, v11
    v_add_u32 v12, 0x10000, v12
    v_add_u32 v13, 0x10000, v13
    s_barrier
    v_mfma_f32_32x32x16_bf16 v[64:79], a[32:35], a[0:3], 0
    ds_read_b64_tr_b16 a[64:65], v10 offset:16384
    ds_read_b64_tr_b16 a[66:67], v10 offset:18432
    v_fma_f32 v52, v52, s66, -v16
    v_fma_f32 v53, v53, s66, -v16
    v_fma_f32 v54, v54, s66, -v16
    v_exp_f32 v52, v52
    v_fma_f32 v55, v55, s66, -v16
    v_exp_f32 v53, v53
    v_mfma_f32_32x32x16_bf16 v[64:79], a[36:39], a[4:7], v[64:79]
    ds_read_b64_tr_b16 a[68:69], v11 offset:16384
    ds_read_b64_tr_b16 a[70:71], v11 offset:18432
    v_fma_f32 v56, v56, s66, -v16
    v_add_f32 v17, v17, v52
    v_exp_f32 v54, v54
    v_fma_f32 v57, v57, s66, -v16
    v_add_f32 v17, v17, v53
    v_cvt_pk_bf16_f32 v42, v52, v53
    v_mfma_f32_32x32x16_bf16 v[64:79], a[40:43], a[8:11], v[64:79]
    ds_read_b64_tr_b16 a[72:73], v12 offset:16384
    ds_read_b64_tr_b16 a[74:75], v12 offset:18432
    v_exp_f32 v55, v55
    v_fma_f32 v58, v58, s66, -v16
    v_add_f32 v17, v17, v54
    v_exp_f32 v56, v56
    v_fma_f32 v59, v59, s66, -v16
    v_add_f32 v17, v17, v55
    v_mfma_f32_32x32x16_bf16 v[64:79], a[44:47], a[12:15], v[64:79]
    ds_read_b64_tr_b16 a[76:77], v13 offset:16384
    ds_read_b64_tr_b16 a[78:79], v13 offset:18432
    v_cvt_pk_bf16_f32 v43, v54, v55
    v_exp_f32 v57, v57
    v_fma_f32 v60, v60, s66, -v16
    v_add_f32 v17, v17, v56
    v_exp_f32 v58, v58
    v_fma_f32 v61, v61, s66, -v16
    v_mfma_f32_32x32x16_bf16 v[64:79], a[48:51], a[16:19], v[64:79]
    ds_read_b64_tr_b16 a[80:81], v10 offset:20480
    ds_read_b64_tr_b16 a[82:83], v10 offset:22528
    v_add_f32 v17, v17, v57
    v_cvt_pk_bf16_f32 v44, v56, v57
    v_exp_f32 v59, v59
    v_fma_f32 v62, v62, s66, -v16
    v_add_f32 v17, v17, v58
    v_exp_f32 v60, v60
    v_mfma_f32_32x32x16_bf16 v[64:79], a[52:55], a[20:23], v[64:79]
    ds_read_b64_tr_b16 a[84:85], v11 offset:20480
    ds_read_b64_tr_b16 a[86:87], v11 offset:22528
    v_fma_f32 v63, v63, s66, -v16
    v_add_f32 v17, v17, v59
    v_cvt_pk_bf16_f32 v45, v58, v59
    v_exp_f32 v61, v61
    v_add_f32 v17, v17, v60
    v_exp_f32 v62, v62
    v_mfma_f32_32x32x16_bf16 v[64:79], a[56:59], a[24:27], v[64:79]
    ds_read_b64_tr_b16 a[88:89], v12 offset:20480
    ds_read_b64_tr_b16 a[90:91], v12 offset:22528
    v_add_f32 v17, v17, v61
    v_cvt_pk_bf16_f32 v46, v60, v61
    v_exp_f32 v63, v63
    v_add_f32 v17, v17, v62
    s_nop 0
    v_add_f32 v17, v17, v63
    v_mfma_f32_32x32x16_bf16 v[64:79], a[60:63], a[28:31], v[64:79]
    ds_read_b64_tr_b16 a[92:93], v13 offset:20480
    ds_read_b64_tr_b16 a[94:95], v13 offset:22528
    v_cvt_pk_bf16_f32 v47, v62, v63
    s_waitcnt lgkmcnt(0)
    v_mfma_f32_32x32x16_bf16 v[80:95], a[64:67], v[40:43], v[80:95]
    ds_read_b128 a[32:35], v2 offset:32768
    ds_read_b128 a[36:39], v3 offset:32768
    ds_read_b128 a[40:43], v4 offset:32768
    v_mfma_f32_32x32x16_bf16 v[96:111], a[68:71], v[40:43], v[96:111]
    ds_read_b128 a[44:47], v5 offset:32768
    ds_read_b128 a[48:51], v6 offset:32768
    ds_read_b128 a[52:55], v7 offset:32768
    v_mfma_f32_32x32x16_bf16 v[112:127], a[72:75], v[40:43], v[112:127]
    ds_read_b128 a[56:59], v8 offset:32768
    ds_read_b128 a[60:63], v9 offset:32768
    v_max3_f32 v15, v64, v65, v66
    v_max3_f32 v18, v67, v68, v69
    v_max3_f32 v15, v15, v70, v71
    v_max3_f32 v18, v18, v72, v73
    v_max3_f32 v15, v15, v74, v75
    v_mfma_f32_32x32x16_bf16 v[128:143], a[76:79], v[40:43], v[128:143]
    v_max3_f32 v18, v18, v76, v77
    v_max3_f32 v15, v15, v78, v79
    v_max_f32 v15, v15, v18
    v_mov_b32 v18, v15
    s_nop 1
    v_mfma_f32_32x32x16_bf16 v[80:95], a[80:83], v[44:47], v[80:95]
    v_permlane32_swap_b32 v15, v18
    s_nop 1
    v_max_f32 v15, v15, v18
    v_mul_f32 v15, s66, v15
    v_mfma_f32_32x32x16_bf16 v[96:111], a[84:87], v[44:47], v[96:111]
    v_sub_f32 v18, v15, v16
    v_cmp_lt_f32 vcc, s67, v18
    s_cbranch_vccz L_nors_c14
    v_max_f32 v18, v15, v16
    v_sub_f32 v19, v16, v18
    v_exp_f32 v19, v19
    v_mov_b32 v16, v18
    s_mov_b32 s60, 1
    v_mul_f32 v17, v17, v19
L_nors_c14:
    v_fma_f32 v64, v64, s66, -v16
    v_fma_f32 v65, v65, s66, -v16
    v_fma_f32 v66, v66, s66, -v16
    v_exp_f32 v64, v64
    v_fma_f32 v67, v67, s66, -v16
    v_mfma_f32_32x32x16_bf16 v[112:127], a[88:91], v[44:47], v[112:127]
    v_exp_f32 v65, v65
    v_add_f32 v17, v17, v64
    v_exp_f32 v66, v66
    v_add_f32 v17, v17, v65
    v_cvt_pk_bf16_f32 v144, v64, v65
    v_mfma_f32_32x32x16_bf16 v[128:143], a[92:95], v[44:47], v[128:143]
    v_exp_f32 v67, v67
    v_add_f32 v17, v17, v66
    s_nop 0
    v_add_f32 v17, v17, v67
    v_cvt_pk_bf16_f32 v145, v66, v67
    s_cmp_eq_u32 s60, 0
    s_cbranch_scc1 L_nopend_c15
    s_nop 7
    s_nop 7
    v_mul_f32 v80, v80, v19
    v_mul_f32 v81, v81, v19
    v_mul_f32 v82, v82, v19
    v_mul_f32 v83, v83, v19
    v_mul_f32 v84, v84, v19
    v_mul_f32 v85, v85, v19
    v_mul_f32 v86, v86, v19
    v_mul_f32 v87, v87, v19
    v_mul_f32 v88, v88, v19
    v_mul_f32 v89, v89, v19
    v_mul_f32 v90, v90, v19
    v_mul_f32 v91, v91, v19
    v_mul_f32 v92, v92, v19
    v_mul_f32 v93, v93, v19
    v_mul_f32 v94, v94, v19
    v_mul_f32 v95, v95, v19
    v_mul_f32 v96, v96, v19
    v_mul_f32 v97, v97, v19
    v_mul_f32 v98, v98, v19
    v_mul_f32 v99, v99, v19
    v_mul_f32 v100, v100, v19
    v_mul_f32 v101, v101, v19
    v_mul_f32 v102, v102, v19
    v_mul_f32 v103, v103, v19
    v_mul_f32 v104, v104, v19
    v_mul_f32 v105, v105, v19
    v_mul_f32 v106, v106, v19
    v_mul_f32 v107, v107, v19
    v_mul_f32 v108, v108, v19
    v_mul_f32 v109, v109, v19
    v_mul_f32 v110, v110, v19
    v_mul_f32 v111, v111, v19
    v_mul_f32 v112, v112, v19
    v_mul_f32 v113, v113, v19
    v_mul_f32 v114, v114, v19
    v_mul_f32 v115, v115, v19
    v_mul_f32 v116, v116, v19
    v_mul_f32 v117, v117, v19
    v_mul_f32 v118, v118, v19
    v_mul_f32 v119, v119, v19
    v_mul_f32 v120, v120, v19
    v_mul_f32 v121, v121, v19
    v_mul_f32 v122, v122, v19
    v_mul_f32 v123, v123, v19
    v_mul_f32 v124, v124, v19
    v_mul_f32 v125, v125, v19
    v_mul_f32 v126, v126, v19
    v_mul_f32 v127, v127, v19
    v_mul_f32 v128, v128, v19
    v_mul_f32 v129, v129, v19
    v_mul_f32 v130, v130, v19
    v_mul_f32 v131, v131, v19
    v_mul_f32 v132, v132, v19
    v_mul_f32 v133, v133, v19
    v_mul_f32 v134, v134, v19
    v_mul_f32 v135, v135, v19
    v_mul_f32 v136, v136, v19
    v_mul_f32 v137, v137, v19
    v_mul_f32 v138, v138, v19
    v_mul_f32 v139, v139, v19
    v_mul_f32 v140, v140, v19
    v_mul_f32 v141, v141, v19
    v_mul_f32 v142, v142, v19
    v_mul_f32 v143, v143, v19
    s_mov_b32 s60, 0
    s_nop 1
L_nopend_c15:
    s_waitcnt lgkmcnt(0)
    s_barrier
    v_mfma_f32_32x32x16_bf16 v[48:63], a[32:35], a[0:3], 0
    ds_read_b64_tr_b16 a[64:65], v10 offset:49152
    ds_read_b64_tr_b16 a[66:67], v10 offset:51200
    v_fma_f32 v68, v68, s66, -v16
    v_fma_f32 v69, v69, s66, -v16
    v_fma_f32 v70, v70, s66, -v16
    v_exp_f32 v68, v68
    v_fma_f32 v71, v71, s66, -v16
    v_exp_f32 v69, v69
    v_mfma_f32_32x32x16_bf16 v[48:63], a[36:39], a[4:7], v[48:63]
    ds_read_b64_tr_b16 a[68:69], v11 offset:49152
    ds_read_b64_tr_b16 a[70:71], v11 offset:51200
    v_fma_f32 v72, v72, s66, -v16
    v_add_f32 v17, v17, v68
    v_exp_f32 v70, v70
    v_fma_f32 v73, v73, s66, -v16
    v_add_f32 v17, v17, v69
    v_cvt_pk_bf16_f32 v146, v68, v69
    v_mfma_f32_32x32x16_bf16 v[48:63], a[40:43], a[8:11], v[48:63]
    ds_read_b64_tr_b16 a[72:73], v12 offset:49152
    ds_read_b64_tr_b16 a[74:75], v12 offset:51200
    v_exp_f32 v71, v71
    v_fma_f32 v74, v74, s66, -v16
    v_add_f32 v17, v17, v70
    v_exp_f32 v72, v72
    v_fma_f32 v75, v75, s66, -v16
    v_add_f32 v17, v17, v71
    v_mfma_f32_32x32x16_bf16 v[48:63], a[44:47], a[12:15], v[48:63]
    ds_read_b64_tr_b16 a[76:77], v13 offset:49152
    ds_read_b64_tr_b16 a[78:79], v13 offset:51200
    v_cvt_pk_bf16_f32 v147, v70, v71
    v_exp_f32 v73, v73
    v_fma_f32 v76, v76, s66, -v16
    v_add_f32 v17, v17, v72
    v_exp_f32 v74, v74
    v_fma_f32 v77, v77, s66, -v16
    v_mfma_f32_32x32x16_bf16 v[48:63], a[48:51], a[16:19], v[48:63]
    ds_read_b64_tr_b16 a[80:81], v10 offset:53248
    ds_read_b64_tr_b16 a[82:83], v10 offset:55296
    v_add_f32 v17, v17, v73
    v_cvt_pk_bf16_f32 v148, v72, v73
    v_exp_f32 v75, v75
    v_fma_f32 v78, v78, s66, -v16
    v_add_f32 v17, v17, v74
    v_exp_f32 v76, v76
    v_mfma_f32_32x32x16_bf16 v[48:63], a[52:55], a[20:23], v[48:63]
    ds_read_b64_tr_b16 a[84:85], v11 offset:53248
    ds_read_b64_tr_b16 a[86:87], v11 offset:55296
    v_fma_f32 v79, v79, s66, -v16
    v_add_f32 v17, v17, v75
    v_cvt_pk_bf16_f32 v149, v74, v75
    v_exp_f32 v77, v77
    v_add_f32 v17, v17, v76
    v_exp_f32 v78, v78
    v_mfma_f32_32x32x16_bf16 v[48:63], a[56:59], a[24:27], v[48:63]
    ds_read_b64_tr_b16 a[88:89], v12 offset:53248
    ds_read_b64_tr_b16 a[90:91], v12 offset:55296
    v_add_f32 v17, v17, v77
    v_cvt_pk_bf16_f32 v150, v76, v77
    v_exp_f32 v79, v79
    v_add_f32 v17, v17, v78
    s_nop 0
    v_add_f32 v17, v17, v79
    v_mfma_f32_32x32x16_bf16 v[48:63], a[60:63], a[28:31], v[48:63]
    ds_read_b64_tr_b16 a[92:93], v13 offset:53248
    ds_read_b64_tr_b16 a[94:95], v13 offset:55296
    v_cvt_pk_bf16_f32 v151, v78, v79
    v_add_u32 v2, 0x10000, v2
    v_add_u32 v3, 0x10000, v3
    v_add_u32 v4, 0x10000, v4
    v_add_u32 v5, 0x10000, v5
    v_add_u32 v6, 0x10000, v6
    v_add_u32 v7, 0x10000, v7
    v_add_u32 v8, 0x10000, v8
    v_add_u32 v9, 0x10000, v9
    s_waitcnt lgkmcnt(0)
    v_mfma_f32_32x32x16_bf16 v[80:95], a[64:67], v[144:147], v[80:95]
    ds_read_b128 a[32:35], v2 offset:0
    ds_read_b128 a[36:39], v3 offset:0
    ds_read_b128 a[40:43], v4 offset:0
    v_mfma_f32_32x32x16_bf16 v[96:111], a[68:71], v[144:147], v[96:111]
    ds_read_b128 a[44:47], v5 offset:0
    ds_read_b128 a[48:51], v6 offset:0
    ds_read_b128 a[52:55], v7 offset:0
    v_mfma_f32_32x32x16_bf16 v[112:127], a[72:75], v[144:147], v[112:127]
    ds_read_b128 a[56:59], v8 offset:0
    ds_read_b128 a[60:63], v9 offset:0
    v_max3_f32 v15, v48, v49, v50
    v_max3_f32 v18, v51, v52, v53
    v_max3_f32 v15, v15, v54, v55
    v_max3_f32 v18, v18, v56, v57
    v_max3_f32 v15, v15, v58, v59
    v_mfma_f32_32x32x16_bf16 v[128:143], a[76:79], v[144:147], v[128:143]
    v_max3_f32 v18, v18, v60, v61
    v_max3_f32 v15, v15, v62, v63
    v_max_f32 v15, v15, v18
    v_mov_b32 v18, v15
    s_nop 1
    v_mfma_f32_32x32x16_bf16 v[80:95], a[80:83], v[148:151], v[80:95]
    v_permlane32_swap_b32 v15, v18
    s_nop 1
    v_max_f32 v15, v15, v18
    v_mul_f32 v15, s66, v15
    v_mfma_f32_32x32x16_bf16 v[96:111], a[84:87], v[148:151], v[96:111]
    v_sub_f32 v18, v15, v16
    v_cmp_lt_f32 vcc, s67, v18
    s_cbranch_vccz L_nors_c16
    v_max_f32 v18, v15, v16
    v_sub_f32 v19, v16, v18
    v_exp_f32 v19, v19
    v_mov_b32 v16, v18
    s_mov_b32 s60, 1
    v_mul_f32 v17, v17, v19
L_nors_c16:
    v_fma_f32 v48, v48, s66, -v16
    v_fma_f32 v49, v49, s66, -v16
    v_fma_f32 v50, v50, s66, -v16
    v_exp_f32 v48, v48
    v_fma_f32 v51, v51, s66, -v16
    v_mfma_f32_32x32x16_bf16 v[112:127], a[88:91], v[148:151], v[112:127]
    v_exp_f32 v49, v49
    v_add_f32 v17, v17, v48
    v_exp_f32 v50, v50
    v_add_f32 v17, v17, v49
    v_cvt_pk_bf16_f32 v40, v48, v49
    v_mfma_f32_32x32x16_bf16 v[128:143], a[92:95], v[148:151], v[128:143]
    v_exp_f32 v51, v51
    v_add_f32 v17, v17, v50
    s_nop 0
    v_add_f32 v17, v17, v51
    v_cvt_pk_bf16_f32 v41, v50, v51
    s_cmp_eq_u32 s60, 0
    s_cbranch_scc1 L_nopend_c17
    s_nop 7
    s_nop 7
    v_mul_f32 v80, v80, v19
    v_mul_f32 v81, v81, v19
    v_mul_f32 v82, v82, v19
    v_mul_f32 v83, v83, v19
    v_mul_f32 v84, v84, v19
    v_mul_f32 v85, v85, v19
    v_mul_f32 v86, v86, v19
    v_mul_f32 v87, v87, v19
    v_mul_f32 v88, v88, v19
    v_mul_f32 v89, v89, v19
    v_mul_f32 v90, v90, v19
    v_mul_f32 v91, v91, v19
    v_mul_f32 v92, v92, v19
    v_mul_f32 v93, v93, v19
    v_mul_f32 v94, v94, v19
    v_mul_f32 v95, v95, v19
    v_mul_f32 v96, v96, v19
    v_mul_f32 v97, v97, v19
    v_mul_f32 v98, v98, v19
    v_mul_f32 v99, v99, v19
    v_mul_f32 v100, v100, v19
    v_mul_f32 v101, v101, v19
    v_mul_f32 v102, v102, v19
    v_mul_f32 v103, v103, v19
    v_mul_f32 v104, v104, v19
    v_mul_f32 v105, v105, v19
    v_mul_f32 v106, v106, v19
    v_mul_f32 v107, v107, v19
    v_mul_f32 v108, v108, v19
    v_mul_f32 v109, v109, v19
    v_mul_f32 v110, v110, v19
    v_mul_f32 v111, v111, v19
    v_mul_f32 v112, v112, v19
    v_mul_f32 v113, v113, v19
    v_mul_f32 v114, v114, v19
    v_mul_f32 v115, v115, v19
    v_mul_f32 v116, v116, v19
    v_mul_f32 v117, v117, v19
    v_mul_f32 v118, v118, v19
    v_mul_f32 v119, v119, v19
    v_mul_f32 v120, v120, v19
    v_mul_f32 v121, v121, v19
    v_mul_f32 v122, v122, v19
    v_mul_f32 v123, v123, v19
    v_mul_f32 v124, v124, v19
    v_mul_f32 v125, v125, v19
    v_mul_f32 v126, v126, v19
    v_mul_f32 v127, v127, v19
    v_mul_f32 v128, v128, v19
    v_mul_f32 v129, v129, v19
    v_mul_f32 v130, v130, v19
    v_mul_f32 v131, v131, v19
    v_mul_f32 v132, v132, v19
    v_mul_f32 v133, v133, v19
    v_mul_f32 v134, v134, v19
    v_mul_f32 v135, v135, v19
    v_mul_f32 v136, v136, v19
    v_mul_f32 v137, v137, v19
    v_mul_f32 v138, v138, v19
    v_mul_f32 v139, v139, v19
    v_mul_f32 v140, v140, v19
    v_mul_f32 v141, v141, v19
    v_mul_f32 v142, v142, v19
    v_mul_f32 v143, v143, v19
    s_mov_b32 s60, 0
    s_nop 1
L_nopend_c17:
    s_waitcnt lgkmcnt(0)
    v_add_u32 v10, 0x10000, v10
    v_add_u32 v11, 0x10000, v11
    v_add_u32 v12, 0x10000, v12
    v_add_u32 v13, 0x10000, v13
    s_barrier
    v_mfma_f32_32x32x16_bf16 v[64:79], a[32:35], a[0:3], 0
    ds_read_b64_tr_b16 a[64:65], v10 offset:16384
    ds_read_b64_tr_b16 a[66:67], v10 offset:18432
    v_fma_f32 v52, v52, s66, -v16
    v_fma_f32 v53, v53, s66, -v16
    v_fma_f32 v54, v54, s66, -v16
    v_exp_f32 v52, v52
    v_fma_f32 v55, v55, s66, -v16
    v_exp_f32 v53, v53
    v_mfma_f32_32x32x16_bf16 v[64:79], a[36:39], a[4:7], v[64:79]
    ds_read_b64_tr_b16 a[68:69], v11 offset:16384
    ds_read_b64_tr_b16 a[70:71], v11 offset:18432
    v_fma_f32 v56, v56, s66, -v16
    v_add_f32 v17, v17, v52
    v_exp_f32 v54, v54
    v_fma_f32 v57, v57, s66, -v16
    v_add_f32 v17, v17, v53
    v_cvt_pk_bf16_f32 v42, v52, v53
    v_mfma_f32_32x32x16_bf16 v[64:79], a[40:43], a[8:11], v[64:79]
    ds_read_b64_tr_b16 a[72:73], v12 offset:16384
    ds_read_b64_tr_b16 a[74:75], v12 offset:18432
    v_exp_f32 v55, v55
    v_fma_f32 v58, v58, s66, -v16
    v_add_f32 v17, v17, v54
    v_exp_f32 v56, v56
    v_fma_f32 v59, v59, s66, -v16
    v_add_f32 v17, v17, v55
    v_mfma_f32_32x32x16_bf16 v[64:79], a[44:47], a[12:15], v[64:79]
    ds_read_b64_tr_b16 a[76:77], v13 offset:16384
    ds_read_b64_tr_b16 a[78:79], v13 offset:18432
    v_cvt_pk_bf16_f32 v43, v54, v55
    v_exp_f32 v57, v57
    v_fma_f32 v60, v60, s66, -v16
    v_add_f32 v17, v17, v56
    v_exp_f32 v58, v58
    v_fma_f32 v61, v61, s66, -v16
    v_mfma_f32_32x32x16_bf16 v[64:79], a[48:51], a[16:19], v[64:79]
    ds_read_b64_tr_b16 a[80:81], v10 offset:20480
    ds_read_b64_tr_b16 a[82:83], v10 offset:22528
    v_add_f32 v17, v17, v57
    v_cvt_pk_bf16_f32 v44, v56, v57
    v_exp_f32 v59, v59
    v_fma_f32 v62, v62, s66, -v16
    v_add_f32 v17, v17, v58
    v_exp_f32 v60, v60
    v_mfma_f32_32x32x16_bf16 v[64:79], a[52:55], a[20:23], v[64:79]
    ds_read_b64_tr_b16 a[84:85], v11 offset:20480
    ds_read_b64_tr_b16 a[86:87], v11 offset:22528
    v_fma_f32 v63, v63, s66, -v16
    v_add_f32 v17, v17, v59
    v_cvt_pk_bf16_f32 v45, v58, v59
    v_exp_f32 v61, v61
    v_add_f32 v17, v17, v60
    v_exp_f32 v62, v62
    v_mfma_f32_32x32x16_bf16 v[64:79], a[56:59], a[24:27], v[64:79]
    ds_read_b64_tr_b16 a[88:89], v12 offset:20480
    ds_read_b64_tr_b16 a[90:91], v12 offset:22528
    v_add_f32 v17, v17, v61
    v_cvt_pk_bf16_f32 v46, v60, v61
    v_exp_f32 v63, v63
    v_add_f32 v17, v17, v62
    s_nop 0
    v_add_f32 v17, v17, v63
    v_mfma_f32_32x32x16_bf16 v[64:79], a[60:63], a[28:31], v[64:79]
    ds_read_b64_tr_b16 a[92:93], v13 offset:20480
    ds_read_b64_tr_b16 a[94:95], v13 offset:22528
    v_cvt_pk_bf16_f32 v47, v62, v63
    v_subrev_u32 v2, 0x20000, v2
    v_subrev_u32 v3, 0x20000, v3
    v_subrev_u32 v4, 0x20000, v4
    v_subrev_u32 v5, 0x20000, v5
    v_subrev_u32 v6, 0x20000, v6
    v_subrev_u32 v7, 0x20000, v7
    v_subrev_u32 v8, 0x20000, v8
    v_subrev_u32 v9, 0x20000, v9
    s_waitcnt lgkmcnt(0)
    v_mfma_f32_32x32x16_bf16 v[80:95], a[64:67], v[40:43], v[80:95]
    ds_read_b128 a[32:35], v2 offset:0
    ds_read_b128 a[36:39], v3 offset:0
    ds_read_b128 a[40:43], v4 offset:0
    v_mfma_f32_32x32x16_bf16 v[96:111], a[68:71], v[40:43], v[96:111]
    ds_read_b128 a[44:47], v5 offset:0
    ds_read_b128 a[48:51], v6 offset:0
    ds_read_b128 a[52:55], v7 offset:0
    v_mfma_f32_32x32x16_bf16 v[112:127], a[72:75], v[40:43], v[112:127]
    ds_read_b128 a[56:59], v8 offset:0
    ds_read_b128 a[60:63], v9 offset:0
    v_max3_f32 v15, v64, v65, v66
    v_max3_f32 v18, v67, v68, v69
    v_max3_f32 v15, v15, v70, v71
    v_max3_f32 v18, v18, v72, v73
    v_max3_f32 v15, v15, v74, v75
    v_mfma_f32_32x32x16_bf16 v[128:143], a[76:79], v[40:43], v[128:143]
    v_max3_f32 v18, v18, v76, v77
    v_max3_f32 v15, v15, v78, v79
    v_max_f32 v15, v15, v18
    v_mov_b32 v18, v15
    s_nop 1
    v_mfma_f32_32x32x16_bf16 v[80:95], a[80:83], v[44:47], v[80:95]
    v_permlane32_swap_b32 v15, v18
    s_nop 1
    v_max_f32 v15, v15, v18
    v_mul_f32 v15, s66, v15
    v_mfma_f32_32x32x16_bf16 v[96:111], a[84:87], v[44:47], v[96:111]
    v_sub_f32 v18, v15, v16
    v_cmp_lt_f32 vcc, s67, v18
    s_cbranch_vccz L_nors_c18
    v_max_f32 v18, v15, v16
    v_sub_f32 v19, v16, v18
    v_exp_f32 v19, v19
    v_mov_b32 v16, v18
    s_mov_b32 s60, 1
    v_mul_f32 v17, v17, v19
L_nors_c18:
    v_fma_f32 v64, v64, s66, -v16
    v_fma_f32 v65, v65, s66, -v16
    v_fma_f32 v66, v66, s66, -v16
    v_exp_f32 v64, v64
    v_fma_f32 v67, v67, s66, -v16
    v_mfma_f32_32x32x16_bf16 v[112:127], a[88:91], v[44:47], v[112:127]
    v_exp_f32 v65, v65
    v_add_f32 v17, v17, v64
    v_exp_f32 v66, v66
    v_add_f32 v17, v17, v65
    v_cvt_pk_bf16_f32 v144, v64, v65
    v_mfma_f32_32x32x16_bf16 v[128:143], a[92:95], v[44:47], v[128:143]
    v_exp_f32 v67, v67
    v_add_f32 v17, v17, v66
    s_nop 0
    v_add_f32 v17, v17, v67
    v_cvt_pk_bf16_f32 v145, v66, v67
    s_cmp_eq_u32 s60, 0
    s_cbranch_scc1 L_nopend_c19
    s_nop 7
    s_nop 7
    v_mul_f32 v80, v80, v19
    v_mul_f32 v81, v81, v19
    v_mul_f32 v82, v82, v19
    v_mul_f32 v83, v83, v19
    v_mul_f32 v84, v84, v19
    v_mul_f32 v85, v85, v19
    v_mul_f32 v86, v86, v19
    v_mul_f32 v87, v87, v19
    v_mul_f32 v88, v88, v19
    v_mul_f32 v89, v89, v19
    v_mul_f32 v90, v90, v19
    v_mul_f32 v91, v91, v19
    v_mul_f32 v92, v92, v19
    v_mul_f32 v93, v93, v19
    v_mul_f32 v94, v94, v19
    v_mul_f32 v95, v95, v19
    v_mul_f32 v96, v96, v19
    v_mul_f32 v97, v97, v19
    v_mul_f32 v98, v98, v19
    v_mul_f32 v99, v99, v19
    v_mul_f32 v100, v100, v19
    v_mul_f32 v101, v101, v19
    v_mul_f32 v102, v102, v19
    v_mul_f32 v103, v103, v19
    v_mul_f32 v104, v104, v19
    v_mul_f32 v105, v105, v19
    v_mul_f32 v106, v106, v19
    v_mul_f32 v107, v107, v19
    v_mul_f32 v108, v108, v19
    v_mul_f32 v109, v109, v19
    v_mul_f32 v110, v110, v19
    v_mul_f32 v111, v111, v19
    v_mul_f32 v112, v112, v19
    v_mul_f32 v113, v113, v19
    v_mul_f32 v114, v114, v19
    v_mul_f32 v115, v115, v19
    v_mul_f32 v116, v116, v19
    v_mul_f32 v117, v117, v19
    v_mul_f32 v118, v118, v19
    v_mul_f32 v119, v119, v19
    v_mul_f32 v120, v120, v19
    v_mul_f32 v121, v121, v19
    v_mul_f32 v122, v122, v19
    v_mul_f32 v123, v123, v19
    v_mul_f32 v124, v124, v19
    v_mul_f32 v125, v125, v19
    v_mul_f32 v126, v126, v19
    v_mul_f32 v127, v127, v19
    v_mul_f32 v128, v128, v19
    v_mul_f32 v129, v129, v19
    v_mul_f32 v130, v130, v19
    v_mul_f32 v131, v131, v19
    v_mul_f32 v132, v132, v19
    v_mul_f32 v133, v133, v19
    v_mul_f32 v134, v134, v19
    v_mul_f32 v135, v135, v19
    v_mul_f32 v136, v136, v19
    v_mul_f32 v137, v137, v19
    v_mul_f32 v138, v138, v19
    v_mul_f32 v139, v139, v19
    v_mul_f32 v140, v140, v19
    v_mul_f32 v141, v141, v19
    v_mul_f32 v142, v142, v19
    v_mul_f32 v143, v143, v19
    s_mov_b32 s60, 0
    s_nop 1
L_nopend_c19:
    s_waitcnt lgkmcnt(0)
    v_subrev_u32 v10, 0x20000, v10
    v_subrev_u32 v11, 0x20000, v11
    v_subrev_u32 v12, 0x20000, v12
    v_subrev_u32 v13, 0x20000, v13
    s_barrier
    v_mfma_f32_32x32x16_bf16 v[48:63], a[32:35], a[0:3], 0
    ds_read_b64_tr_b16 a[64:65], v10 offset:16384
    ds_read_b64_tr_b16 a[66:67], v10 offset:18432
    v_fma_f32 v68, v68, s66, -v16
    v_fma_f32 v69, v69, s66, -v16
    v_fma_f32 v70, v70, s66, -v16
    v_exp_f32 v68, v68
    v_fma_f32 v71, v71, s66, -v16
    v_exp_f32 v69, v69
    v_mfma_f32_32x32x16_bf16 v[48:63], a[36:39], a[4:7], v[48:63]
    ds_read_b64_tr_b16 a[68:69], v11 offset:16384
    ds_read_b64_tr_b16 a[70:71], v11 offset:18432
    v_fma_f32 v72, v72, s66, -v16
    v_add_f32 v17, v17, v68
    v_exp_f32 v70, v70
    v_fma_f32 v73, v73, s66, -v16
    v_add_f32 v17, v17, v69
    v_cvt_pk_bf16_f32 v146, v68, v69
    v_mfma_f32_32x32x16_bf16 v[48:63], a[40:43], a[8:11], v[48:63]
    ds_read_b64_tr_b16 a[72:73], v12 offset:16384
    ds_read_b64_tr_b16 a[74:75], v12 offset:18432
    v_exp_f32 v71, v71
    v_fma_f32 v74, v74, s66, -v16
    v_add_f32 v17, v17, v70
    v_exp_f32 v72, v72
    v_fma_f32 v75, v75, s66, -v16
    v_add_f32 v17, v17, v71
    v_mfma_f32_32x32x16_bf16 v[48:63], a[44:47], a[12:15], v[48:63]
    ds_read_b64_tr_b16 a[76:77], v13 offset:16384
    ds_read_b64_tr_b16 a[78:79], v13 offset:18432
    v_cvt_pk_bf16_f32 v147, v70, v71
    v_exp_f32 v73, v73
    v_fma_f32 v76, v76, s66, -v16
    v_add_f32 v17, v17, v72
    v_exp_f32 v74, v74
    v_fma_f32 v77, v77, s66, -v16
    v_mfma_f32_32x32x16_bf16 v[48:63], a[48:51], a[16:19], v[48:63]
    ds_read_b64_tr_b16 a[80:81], v10 offset:20480
    ds_read_b64_tr_b16 a[82:83], v10 offset:22528
    v_add_f32 v17, v17, v73
    v_cvt_pk_bf16_f32 v148, v72, v73
    v_exp_f32 v75, v75
    v_fma_f32 v78, v78, s66, -v16
    v_add_f32 v17, v17, v74
    v_exp_f32 v76, v76
    v_mfma_f32_32x32x16_bf16 v[48:63], a[52:55], a[20:23], v[48:63]
    ds_read_b64_tr_b16 a[84:85], v11 offset:20480
    ds_read_b64_tr_b16 a[86:87], v11 offset:22528
    v_fma_f32 v79, v79, s66, -v16
    v_add_f32 v17, v17, v75
    v_cvt_pk_bf16_f32 v149, v74, v75
    v_exp_f32 v77, v77
    v_add_f32 v17, v17, v76
    v_exp_f32 v78, v78
    v_mfma_f32_32x32x16_bf16 v[48:63], a[56:59], a[24:27], v[48:63]
    ds_read_b64_tr_b16 a[88:89], v12 offset:20480
    ds_read_b64_tr_b16 a[90:91], v12 offset:22528
    v_add_f32 v17, v17, v77
    v_cvt_pk_bf16_f32 v150, v76, v77
    v_exp_f32 v79, v79
    v_add_f32 v17, v17, v78
    s_nop 0
    v_add_f32 v17, v17, v79
    v_mfma_f32_32x32x16_bf16 v[48:63], a[60:63], a[28:31], v[48:63]
    ds_read_b64_tr_b16 a[92:93], v13 offset:20480
    ds_read_b64_tr_b16 a[94:95], v13 offset:22528
    v_cvt_pk_bf16_f32 v151, v78, v79
    s_waitcnt lgkmcnt(0)
    v_mfma_f32_32x32x16_bf16 v[80:95], a[64:67], v[144:147], v[80:95]
    ds_read_b128 a[32:35], v2 offset:32768
    ds_read_b128 a[36:39], v3 offset:32768
    ds_read_b128 a[40:43], v4 offset:32768
    v_mfma_f32_32x32x16_bf16 v[96:111], a[68:71], v[144:147], v[96:111]
    ds_read_b128 a[44:47], v5 offset:32768
    ds_read_b128 a[48:51], v6 offset:32768
    ds_read_b128 a[52:55], v7 offset:32768
    v_mfma_f32_32x32x16_bf16 v[112:127], a[72:75], v[144:147], v[112:127]
    ds_read_b128 a[56:59], v8 offset:32768
    ds_read_b128 a[60:63], v9 offset:32768
    v_max3_f32 v15, v48, v49, v50
    v_max3_f32 v18, v51, v52, v53
    v_max3_f32 v15, v15, v54, v55
    v_max3_f32 v18, v18, v56, v57
    v_max3_f32 v15, v15, v58, v59
    v_mfma_f32_32x32x16_bf16 v[128:143], a[76:79], v[144:147], v[128:143]
    v_max3_f32 v18, v18, v60, v61
    v_max3_f32 v15, v15, v62, v63
    v_max_f32 v15, v15, v18
    v_mov_b32 v18, v15
    s_nop 1
    v_mfma_f32_32x32x16_bf16 v[80:95], a[80:83], v[148:151], v[80:95]
    v_permlane32_swap_b32 v15, v18
    s_nop 1
    v_max_f32 v15, v15, v18
    v_mul_f32 v15, s66, v15
    v_mfma_f32_32x32x16_bf16 v[96:111], a[84:87], v[148:151], v[96:111]
    v_sub_f32 v18, v15, v16
    v_cmp_lt_f32 vcc, s67, v18
    s_cbranch_vccz L_nors_c20
    v_max_f32 v18, v15, v16
    v_sub_f32 v19, v16, v18
    v_exp_f32 v19, v19
    v_mov_b32 v16, v18
    s_mov_b32 s60, 1
    v_mul_f32 v17, v17, v19
L_nors_c20:
    v_fma_f32 v48, v48, s66, -v16
    v_fma_f32 v49, v49, s66, -v16
    v_fma_f32 v50, v50, s66, -v16
    v_exp_f32 v48, v48
    v_fma_f32 v51, v51, s66, -v16
    v_mfma_f32_32x32x16_bf16 v[112:127], a[88:91], v[148:151], v[112:127]
    v_exp_f32 v49, v49
    v_add_f32 v17, v17, v48
    v_exp_f32 v50, v50
    v_add_f32 v17, v17, v49
    v_cvt_pk_bf16_f32 v40, v48, v49
    v_mfma_f32_32x32x16_bf16 v[128:143], a[92:95], v[148:151], v[128:143]
    v_exp_f32 v51, v51
    v_add_f32 v17, v17, v50
    s_nop 0
    v_add_f32 v17, v17, v51
    v_cvt_pk_bf16_f32 v41, v50, v51
    s_cmp_eq_u32 s60, 0
    s_cbranch_scc1 L_nopend_c21
    s_nop 7
    s_nop 7
    v_mul_f32 v80, v80, v19
    v_mul_f32 v81, v81, v19
    v_mul_f32 v82, v82, v19
    v_mul_f32 v83, v83, v19
    v_mul_f32 v84, v84, v19
    v_mul_f32 v85, v85, v19
    v_mul_f32 v86, v86, v19
    v_mul_f32 v87, v87, v19
    v_mul_f32 v88, v88, v19
    v_mul_f32 v89, v89, v19
    v_mul_f32 v90, v90, v19
    v_mul_f32 v91, v91, v19
    v_mul_f32 v92, v92, v19
    v_mul_f32 v93, v93, v19
    v_mul_f32 v94, v94, v19
    v_mul_f32 v95, v95, v19
    v_mul_f32 v96, v96, v19
    v_mul_f32 v97, v97, v19
    v_mul_f32 v98, v98, v19
    v_mul_f32 v99, v99, v19
    v_mul_f32 v100, v100, v19
    v_mul_f32 v101, v101, v19
    v_mul_f32 v102, v102, v19
    v_mul_f32 v103, v103, v19
    v_mul_f32 v104, v104, v19
    v_mul_f32 v105, v105, v19
    v_mul_f32 v106, v106, v19
    v_mul_f32 v107, v107, v19
    v_mul_f32 v108, v108, v19
    v_mul_f32 v109, v109, v19
    v_mul_f32 v110, v110, v19
    v_mul_f32 v111, v111, v19
    v_mul_f32 v112, v112, v19
    v_mul_f32 v113, v113, v19
    v_mul_f32 v114, v114, v19
    v_mul_f32 v115, v115, v19
    v_mul_f32 v116, v116, v19
    v_mul_f32 v117, v117, v19
    v_mul_f32 v118, v118, v19
    v_mul_f32 v119, v119, v19
    v_mul_f32 v120, v120, v19
    v_mul_f32 v121, v121, v19
    v_mul_f32 v122, v122, v19
    v_mul_f32 v123, v123, v19
    v_mul_f32 v124, v124, v19
    v_mul_f32 v125, v125, v19
    v_mul_f32 v126, v126, v19
    v_mul_f32 v127, v127, v19
    v_mul_f32 v128, v128, v19
    v_mul_f32 v129, v129, v19
    v_mul_f32 v130, v130, v19
    v_mul_f32 v131, v131, v19
    v_mul_f32 v132, v132, v19
    v_mul_f32 v133, v133, v19
    v_mul_f32 v134, v134, v19
    v_mul_f32 v135, v135, v19
    v_mul_f32 v136, v136, v19
    v_mul_f32 v137, v137, v19
    v_mul_f32 v138, v138, v19
    v_mul_f32 v139, v139, v19
    v_mul_f32 v140, v140, v19
    v_mul_f32 v141, v141, v19
    v_mul_f32 v142, v142, v19
    v_mul_f32 v143, v143, v19
    s_mov_b32 s60, 0
    s_nop 1
L_nopend_c21:
    s_waitcnt lgkmcnt(0)
    s_barrier
    v_mfma_f32_32x32x16_bf16 v[64:79], a[32:35], a[0:3], 0
    ds_read_b64_tr_b16 a[64:65], v10 offset:49152
    ds_read_b64_tr_b16 a[66:67], v10 offset:51200
    v_fma_f32 v52, v52, s66, -v16
    v_fma_f32 v53, v53, s66, -v16
    v_fma_f32 v54, v54, s66, -v16
    v_exp_f32 v52, v52
    v_fma_f32 v55, v55, s66, -v16
    v_exp_f32 v53, v53
    v_mfma_f32_32x32x16_bf16 v[64:79], a[36:39], a[4:7], v[64:79]
    ds_read_b64_tr_b16 a[68:69], v11 offset:49152
    ds_read_b64_tr_b16 a[70:71], v11 offset:51200
    v_fma_f32 v56, v56, s66, -v16
    v_add_f32 v17, v17, v52
    v_exp_f32 v54, v54
    v_fma_f32 v57, v57, s66, -v16
    v_add_f32 v17, v17, v53
    v_cvt_pk_bf16_f32 v42, v52, v53
    v_mfma_f32_32x32x16_bf16 v[64:79], a[40:43], a[8:11], v[64:79]
    ds_read_b64_tr_b16 a[72:73], v12 offset:49152
    ds_read_b64_tr_b16 a[74:75], v12 offset:51200
    v_exp_f32 v55, v55
    v_fma_f32 v58, v58, s66, -v16
    v_add_f32 v17, v17, v54
    v_exp_f32 v56, v56
    v_fma_f32 v59, v59, s66, -v16
    v_add_f32 v17, v17, v55
    v_mfma_f32_32x32x16_bf16 v[64:79], a[44:47], a[12:15], v[64:79]
    ds_read_b64_tr_b16 a[76:77], v13 offset:49152
    ds_read_b64_tr_b16 a[78:79], v13 offset:51200
    v_cvt_pk_bf16_f32 v43, v54, v55
    v_exp_f32 v57, v57
    v_fma_f32 v60, v60, s66, -v16
    v_add_f32 v17, v17, v56
    v_exp_f32 v58, v58
    v_fma_f32 v61, v61, s66, -v16
    v_mfma_f32_32x32x16_bf16 v[64:79], a[48:51], a[16:19], v[64:79]
    ds_read_b64_tr_b16 a[80:81], v10 offset:53248
    ds_read_b64_tr_b16 a[82:83], v10 offset:55296
    v_add_f32 v17, v17, v57
    v_cvt_pk_bf16_f32 v44, v56, v57
    v_exp_f32 v59, v59
    v_fma_f32 v62, v62, s66, -v16
    v_add_f32 v17, v17, v58
    v_exp_f32 v60, v60
    v_mfma_f32_32x32x16_bf16 v[64:79], a[52:55], a[20:23], v[64:79]
    ds_read_b64_tr_b16 a[84:85], v11 offset:53248
    ds_read_b64_tr_b16 a[86:87], v11 offset:55296
    v_fma_f32 v63, v63, s66, -v16
    v_add_f32 v17, v17, v59
    v_cvt_pk_bf16_f32 v45, v58, v59
    v_exp_f32 v61, v61
    v_add_f32 v17, v17, v60
    v_exp_f32 v62, v62
    v_mfma_f32_32x32x16_bf16 v[64:79], a[56:59], a[24:27], v[64:79]
    ds_read_b64_tr_b16 a[88:89], v12 offset:53248
    ds_read_b64_tr_b16 a[90:91], v12 offset:55296
    v_add_f32 v17, v17, v61
    v_cvt_pk_bf16_f32 v46, v60, v61
    v_exp_f32 v63, v63
    v_add_f32 v17, v17, v62
    s_nop 0
    v_add_f32 v17, v17, v63
    v_mfma_f32_32x32x16_bf16 v[64:79], a[60:63], a[28:31], v[64:79]
    ds_read_b64_tr_b16 a[92:93], v13 offset:53248
    ds_read_b64_tr_b16 a[94:95], v13 offset:55296
    v_cvt_pk_bf16_f32 v47, v62, v63
    v_add_u32 v2, 0x10000, v2
    v_add_u32 v3, 0x10000, v3
    v_add_u32 v4, 0x10000, v4
    v_add_u32 v5, 0x10000, v5
    v_add_u32 v6, 0x10000, v6
    v_add_u32 v7, 0x10000, v7
    v_add_u32 v8, 0x10000, v8
    v_add_u32 v9, 0x10000, v9
    s_waitcnt lgkmcnt(0)
    v_mfma_f32_32x32x16_bf16 v[80:95], a[64:67], v[40:43], v[80:95]
    ds_read_b128 a[32:35], v2 offset:0
    ds_read_b128 a[36:39], v3 offset:0
    ds_read_b128 a[40:43], v4 offset:0
    v_mfma_f32_32x32x16_bf16 v[96:111], a[68:71], v[40:43], v[96:111]
    ds_read_b128 a[44:47], v5 offset:0
    ds_read_b128 a[48:51], v6 offset:0
    ds_read_b128 a[52:55], v7 offset:0
    v_mfma_f32_32x32x16_bf16 v[112:127], a[72:75], v[40:43], v[112:127]
    ds_read_b128 a[56:59], v8 offset:0
    ds_read_b128 a[60:63], v9 offset:0
    v_max3_f32 v15, v64, v65, v66
    v_max3_f32 v18, v67, v68, v69
    v_max3_f32 v15, v15, v70, v71
    v_max3_f32 v18, v18, v72, v73
    v_max3_f32 v15, v15, v74, v75
    v_mfma_f32_32x32x16_bf16 v[128:143], a[76:79], v[40:43], v[128:143]
    v_max3_f32 v18, v18, v76, v77
    v_max3_f32 v15, v15, v78, v79
    v_max_f32 v15, v15, v18
    v_mov_b32 v18, v15
    s_nop 1
    v_mfma_f32_32x32x16_bf16 v[80:95], a[80:83], v[44:47], v[80:95]
    v_permlane32_swap_b32 v15, v18
    s_nop 1
    v_max_f32 v15, v15, v18
    v_mul_f32 v15, s66, v15
    v_mfma_f32_32x32x16_bf16 v[96:111], a[84:87], v[44:47], v[96:111]
    v_sub_f32 v18, v15, v16
    v_cmp_lt_f32 vcc, s67, v18
    s_cbranch_vccz L_nors_c22
    v_max_f32 v18, v15, v16
    v_sub_f32 v19, v16, v18
    v_exp_f32 v19, v19
    v_mov_b32 v16, v18
    s_mov_b32 s60, 1
    v_mul_f32 v17, v17, v19
L_nors_c22:
    v_fma_f32 v64, v64, s66, -v16
    v_fma_f32 v65, v65, s66, -v16
    v_fma_f32 v66, v66, s66, -v16
    v_exp_f32 v64, v64
    v_fma_f32 v67, v67, s66, -v16
    v_mfma_f32_32x32x16_bf16 v[112:127], a[88:91], v[44:47], v[112:127]
    v_exp_f32 v65, v65
    v_add_f32 v17, v17, v64
    v_exp_f32 v66, v66
    v_add_f32 v17, v17, v65
    v_cvt_pk_bf16_f32 v144, v64, v65
    v_mfma_f32_32x32x16_bf16 v[128:143], a[92:95], v[44:47], v[128:143]
    v_exp_f32 v67, v67
    v_add_f32 v17, v17, v66
    s_nop 0
    v_add_f32 v17, v17, v67
    v_cvt_pk_bf16_f32 v145, v66, v67
    s_cmp_eq_u32 s60, 0
    s_cbranch_scc1 L_nopend_c23
    s_nop 7
    s_nop 7
    v_mul_f32 v80, v80, v19
    v_mul_f32 v81, v81, v19
    v_mul_f32 v82, v82, v19
    v_mul_f32 v83, v83, v19
    v_mul_f32 v84, v84, v19
    v_mul_f32 v85, v85, v19
    v_mul_f32 v86, v86, v19
    v_mul_f32 v87, v87, v19
    v_mul_f32 v88, v88, v19
    v_mul_f32 v89, v89, v19
    v_mul_f32 v90, v90, v19
    v_mul_f32 v91, v91, v19
    v_mul_f32 v92, v92, v19
    v_mul_f32 v93, v93, v19
    v_mul_f32 v94, v94, v19
    v_mul_f32 v95, v95, v19
    v_mul_f32 v96, v96, v19
    v_mul_f32 v97, v97, v19
    v_mul_f32 v98, v98, v19
    v_mul_f32 v99, v99, v19
    v_mul_f32 v100, v100, v19
    v_mul_f32 v101, v101, v19
    v_mul_f32 v102, v102, v19
    v_mul_f32 v103, v103, v19
    v_mul_f32 v104, v104, v19
    v_mul_f32 v105, v105, v19
    v_mul_f32 v106, v106, v19
    v_mul_f32 v107, v107, v19
    v_mul_f32 v108, v108, v19
    v_mul_f32 v109, v109, v19
    v_mul_f32 v110, v110, v19
    v_mul_f32 v111, v111, v19
    v_mul_f32 v112, v112, v19
    v_mul_f32 v113, v113, v19
    v_mul_f32 v114, v114, v19
    v_mul_f32 v115, v115, v19
    v_mul_f32 v116, v116, v19
    v_mul_f32 v117, v117, v19
    v_mul_f32 v118, v118, v19
    v_mul_f32 v119, v119, v19
    v_mul_f32 v120, v120, v19
    v_mul_f32 v121, v121, v19
    v_mul_f32 v122, v122, v19
    v_mul_f32 v123, v123, v19
    v_mul_f32 v124, v124, v19
    v_mul_f32 v125, v125, v19
    v_mul_f32 v126, v126, v19
    v_mul_f32 v127, v127, v19
    v_mul_f32 v128, v128, v19
    v_mul_f32 v129, v129, v19
    v_mul_f32 v130, v130, v19
    v_mul_f32 v131, v131, v19
    v_mul_f32 v132, v132, v19
    v_mul_f32 v133, v133, v19
    v_mul_f32 v134, v134, v19
    v_mul_f32 v135, v135, v19
    v_mul_f32 v136, v136, v19
    v_mul_f32 v137, v137, v19
    v_mul_f32 v138, v138, v19
    v_mul_f32 v139, v139, v19
    v_mul_f32 v140, v140, v19
    v_mul_f32 v141, v141, v19
    v_mul_f32 v142, v142, v19
    v_mul_f32 v143, v143, v19
    s_mov_b32 s60, 0
    s_nop 1
L_nopend_c23:
    s_waitcnt lgkmcnt(0)
    v_add_u32 v10, 0x10000, v10
    v_add_u32 v11, 0x10000, v11
    v_add_u32 v12, 0x10000, v12
    v_add_u32 v13, 0x10000, v13
    s_barrier
    v_mfma_f32_32x32x16_bf16 v[48:63], a[32:35], a[0:3], 0
    ds_read_b64_tr_b16 a[64:65], v10 offset:16384
    ds_read_b64_tr_b16 a[66:67], v10 offset:18432
    v_fma_f32 v68, v68, s66, -v16
    v_fma_f32 v69, v69, s66, -v16
    v_fma_f32 v70, v70, s66, -v16
    v_exp_f32 v68, v68
    v_fma_f32 v71, v71, s66, -v16
    v_exp_f32 v69, v69
    v_mfma_f32_32x32x16_bf16 v[48:63], a[36:39], a[4:7], v[48:63]
    ds_read_b64_tr_b16 a[68:69], v11 offset:16384
    ds_read_b64_tr_b16 a[70:71], v11 offset:18432
    v_fma_f32 v72, v72, s66, -v16
    v_add_f32 v17, v17, v68
    v_exp_f32 v70, v70
    v_fma_f32 v73, v73, s66, -v16
    v_add_f32 v17, v17, v69
    v_cvt_pk_bf16_f32 v146, v68, v69
    v_mfma_f32_32x32x16_bf16 v[48:63], a[40:43], a[8:11], v[48:63]
    ds_read_b64_tr_b16 a[72:73], v12 offset:16384
    ds_read_b64_tr_b16 a[74:75], v12 offset:18432
    v_exp_f32 v71, v71
    v_fma_f32 v74, v74, s66, -v16
    v_add_f32 v17, v17, v70
    v_exp_f32 v72, v72
    v_fma_f32 v75, v75, s66, -v16
    v_add_f32 v17, v17, v71
    v_mfma_f32_32x32x16_bf16 v[48:63], a[44:47], a[12:15], v[48:63]
    ds_read_b64_tr_b16 a[76:77], v13 offset:16384
    ds_read_b64_tr_b16 a[78:79], v13 offset:18432
    v_cvt_pk_bf16_f32 v147, v70, v71
    v_exp_f32 v73, v73
    v_fma_f32 v76, v76, s66, -v16
    v_add_f32 v17, v17, v72
    v_exp_f32 v74, v74
    v_fma_f32 v77, v77, s66, -v16
    v_mfma_f32_32x32x16_bf16 v[48:63], a[48:51], a[16:19], v[48:63]
    ds_read_b64_tr_b16 a[80:81], v10 offset:20480
    ds_read_b64_tr_b16 a[82:83], v10 offset:22528
    v_add_f32 v17, v17, v73
    v_cvt_pk_bf16_f32 v148, v72, v73
    v_exp_f32 v75, v75
    v_fma_f32 v78, v78, s66, -v16
    v_add_f32 v17, v17, v74
    v_exp_f32 v76, v76
    v_mfma_f32_32x32x16_bf16 v[48:63], a[52:55], a[20:23], v[48:63]
    ds_read_b64_tr_b16 a[84:85], v11 offset:20480
    ds_read_b64_tr_b16 a[86:87], v11 offset:22528
    v_fma_f32 v79, v79, s66, -v16
    v_add_f32 v17, v17, v75
    v_cvt_pk_bf16_f32 v149, v74, v75
    v_exp_f32 v77, v77
    v_add_f32 v17, v17, v76
    v_exp_f32 v78, v78
    v_mfma_f32_32x32x16_bf16 v[48:63], a[56:59], a[24:27], v[48:63]
    ds_read_b64_tr_b16 a[88:89], v12 offset:20480
    ds_read_b64_tr_b16 a[90:91], v12 offset:22528
    v_add_f32 v17, v17, v77
    v_cvt_pk_bf16_f32 v150, v76, v77
    v_exp_f32 v79, v79
    v_add_f32 v17, v17, v78
    s_nop 0
    v_add_f32 v17, v17, v79
    v_mfma_f32_32x32x16_bf16 v[48:63], a[60:63], a[28:31], v[48:63]
    ds_read_b64_tr_b16 a[92:93], v13 offset:20480
    ds_read_b64_tr_b16 a[94:95], v13 offset:22528
    v_cvt_pk_bf16_f32 v151, v78, v79
    s_waitcnt lgkmcnt(0)
    v_mfma_f32_32x32x16_bf16 v[80:95], a[64:67], v[144:147], v[80:95]
    ds_read_b128 a[32:35], v2 offset:32768
    ds_read_b128 a[36:39], v3 offset:32768
    ds_read_b128 a[40:43], v4 offset:32768
    v_mfma_f32_32x32x16_bf16 v[96:111], a[68:71], v[144:147], v[96:111]
    ds_read_b128 a[44:47], v5 offset:32768
    ds_read_b128 a[48:51], v6 offset:32768
    ds_read_b128 a[52:55], v7 offset:32768
    v_mfma_f32_32x32x16_bf16 v[112:127], a[72:75], v[144:147], v[112:127]
    ds_read_b128 a[56:59], v8 offset:32768
    ds_read_b128 a[60:63], v9 offset:32768
    v_max3_f32 v15, v48, v49, v50
    v_max3_f32 v18, v51, v52, v53
    v_max3_f32 v15, v15, v54, v55
    v_max3_f32 v18, v18, v56, v57
    v_max3_f32 v15, v15, v58, v59
    v_mfma_f32_32x32x16_bf16 v[128:143], a[76:79], v[144:147], v[128:143]
    v_max3_f32 v18, v18, v60, v61
    v_max3_f32 v15, v15, v62, v63
    v_max_f32 v15, v15, v18
    v_mov_b32 v18, v15
    s_nop 1
    v_mfma_f32_32x32x16_bf16 v[80:95], a[80:83], v[148:151], v[80:95]
    v_permlane32_swap_b32 v15, v18
    s_nop 1
    v_max_f32 v15, v15, v18
    v_mul_f32 v15, s66, v15
    v_mfma_f32_32x32x16_bf16 v[96:111], a[84:87], v[148:151], v[96:111]
    v_sub_f32 v18, v15, v16
    v_cmp_lt_f32 vcc, s67, v18
    s_cbranch_vccz L_nors_c24
    v_max_f32 v18, v15, v16
    v_sub_f32 v19, v16, v18
    v_exp_f32 v19, v19
    v_mov_b32 v16, v18
    s_mov_b32 s60, 1
    v_mul_f32 v17, v17, v19
L_nors_c24:
    v_fma_f32 v48, v48, s66, -v16
    v_fma_f32 v49, v49, s66, -v16
    v_fma_f32 v50, v50, s66, -v16
    v_exp_f32 v48, v48
    v_fma_f32 v51, v51, s66, -v16
    v_mfma_f32_32x32x16_bf16 v[112:127], a[88:91], v[148:151], v[112:127]
    v_exp_f32 v49, v49
    v_add_f32 v17, v17, v48
    v_exp_f32 v50, v50
    v_add_f32 v17, v17, v49
    v_cvt_pk_bf16_f32 v40, v48, v49
    v_mfma_f32_32x32x16_bf16 v[128:143], a[92:95], v[148:151], v[128:143]
    v_exp_f32 v51, v51
    v_add_f32 v17, v17, v50
    s_nop 0
    v_add_f32 v17, v17, v51
    v_cvt_pk_bf16_f32 v41, v50, v51
    s_cmp_eq_u32 s60, 0
    s_cbranch_scc1 L_nopend_c25
    s_nop 7
    s_nop 7
    v_mul_f32 v80, v80, v19
    v_mul_f32 v81, v81, v19
    v_mul_f32 v82, v82, v19
    v_mul_f32 v83, v83, v19
    v_mul_f32 v84, v84, v19
    v_mul_f32 v85, v85, v19
    v_mul_f32 v86, v86, v19
    v_mul_f32 v87, v87, v19
    v_mul_f32 v88, v88, v19
    v_mul_f32 v89, v89, v19
    v_mul_f32 v90, v90, v19
    v_mul_f32 v91, v91, v19
    v_mul_f32 v92, v92, v19
    v_mul_f32 v93, v93, v19
    v_mul_f32 v94, v94, v19
    v_mul_f32 v95, v95, v19
    v_mul_f32 v96, v96, v19
    v_mul_f32 v97, v97, v19
    v_mul_f32 v98, v98, v19
    v_mul_f32 v99, v99, v19
    v_mul_f32 v100, v100, v19
    v_mul_f32 v101, v101, v19
    v_mul_f32 v102, v102, v19
    v_mul_f32 v103, v103, v19
    v_mul_f32 v104, v104, v19
    v_mul_f32 v105, v105, v19
    v_mul_f32 v106, v106, v19
    v_mul_f32 v107, v107, v19
    v_mul_f32 v108, v108, v19
    v_mul_f32 v109, v109, v19
    v_mul_f32 v110, v110, v19
    v_mul_f32 v111, v111, v19
    v_mul_f32 v112, v112, v19
    v_mul_f32 v113, v113, v19
    v_mul_f32 v114, v114, v19
    v_mul_f32 v115, v115, v19
    v_mul_f32 v116, v116, v19
    v_mul_f32 v117, v117, v19
    v_mul_f32 v118, v118, v19
    v_mul_f32 v119, v119, v19
    v_mul_f32 v120, v120, v19
    v_mul_f32 v121, v121, v19
    v_mul_f32 v122, v122, v19
    v_mul_f32 v123, v123, v19
    v_mul_f32 v124, v124, v19
    v_mul_f32 v125, v125, v19
    v_mul_f32 v126, v126, v19
    v_mul_f32 v127, v127, v19
    v_mul_f32 v128, v128, v19
    v_mul_f32 v129, v129, v19
    v_mul_f32 v130, v130, v19
    v_mul_f32 v131, v131, v19
    v_mul_f32 v132, v132, v19
    v_mul_f32 v133, v133, v19
    v_mul_f32 v134, v134, v19
    v_mul_f32 v135, v135, v19
    v_mul_f32 v136, v136, v19
    v_mul_f32 v137, v137, v19
    v_mul_f32 v138, v138, v19
    v_mul_f32 v139, v139, v19
    v_mul_f32 v140, v140, v19
    v_mul_f32 v141, v141, v19
    v_mul_f32 v142, v142, v19
    v_mul_f32 v143, v143, v19
    s_mov_b32 s60, 0
    s_nop 1
L_nopend_c25:
    s_waitcnt lgkmcnt(0)
    s_barrier
    v_mfma_f32_32x32x16_bf16 v[64:79], a[32:35], a[0:3], 0
    ds_read_b64_tr_b16 a[64:65], v10 offset:49152
    ds_read_b64_tr_b16 a[66:67], v10 offset:51200
    v_fma_f32 v52, v52, s66, -v16
    v_fma_f32 v53, v53, s66, -v16
    v_fma_f32 v54, v54, s66, -v16
    v_exp_f32 v52, v52
    v_fma_f32 v55, v55, s66, -v16
    v_exp_f32 v53, v53
    v_mfma_f32_32x32x16_bf16 v[64:79], a[36:39], a[4:7], v[64:79]
    ds_read_b64_tr_b16 a[68:69], v11 offset:49152
    ds_read_b64_tr_b16 a[70:71], v11 offset:51200
    v_fma_f32 v56, v56, s66, -v16
    v_add_f32 v17, v17, v52
    v_exp_f32 v54, v54
    v_fma_f32 v57, v57, s66, -v16
    v_add_f32 v17, v17, v53
    v_cvt_pk_bf16_f32 v42, v52, v53
    v_mfma_f32_32x32x16_bf16 v[64:79], a[40:43], a[8:11], v[64:79]
    ds_read_b64_tr_b16 a[72:73], v12 offset:49152
    ds_read_b64_tr_b16 a[74:75], v12 offset:51200
    v_exp_f32 v55, v55
    v_fma_f32 v58, v58, s66, -v16
    v_add_f32 v17, v17, v54
    v_exp_f32 v56, v56
    v_fma_f32 v59, v59, s66, -v16
    v_add_f32 v17, v17, v55
    v_mfma_f32_32x32x16_bf16 v[64:79], a[44:47], a[12:15], v[64:79]
    ds_read_b64_tr_b16 a[76:77], v13 offset:49152
    ds_read_b64_tr_b16 a[78:79], v13 offset:51200
    v_cvt_pk_bf16_f32 v43, v54, v55
    v_exp_f32 v57, v57
    v_fma_f32 v60, v60, s66, -v16
    v_add_f32 v17, v17, v56
    v_exp_f32 v58, v58
    v_fma_f32 v61, v61, s66, -v16
    v_mfma_f32_32x32x16_bf16 v[64:79], a[48:51], a[16:19], v[64:79]
    ds_read_b64_tr_b16 a[80:81], v10 offset:53248
    ds_read_b64_tr_b16 a[82:83], v10 offset:55296
    v_add_f32 v17, v17, v57
    v_cvt_pk_bf16_f32 v44, v56, v57
    v_exp_f32 v59, v59
    v_fma_f32 v62, v62, s66, -v16
    v_add_f32 v17, v17, v58
    v_exp_f32 v60, v60
    v_mfma_f32_32x32x16_bf16 v[64:79], a[52:55], a[20:23], v[64:79]
    ds_read_b64_tr_b16 a[84:85], v11 offset:53248
    ds_read_b64_tr_b16 a[86:87], v11 offset:55296
    v_fma_f32 v63, v63, s66, -v16
    v_add_f32 v17, v17, v59
    v_cvt_pk_bf16_f32 v45, v58, v59
    v_exp_f32 v61, v61
    v_add_f32 v17, v17, v60
    v_exp_f32 v62, v62
    v_mfma_f32_32x32x16_bf16 v[64:79], a[56:59], a[24:27], v[64:79]
    ds_read_b64_tr_b16 a[88:89], v12 offset:53248
    ds_read_b64_tr_b16 a[90:91], v12 offset:55296
    v_add_f32 v17, v17, v61
    v_cvt_pk_bf16_f32 v46, v60, v61
    v_exp_f32 v63, v63
    v_add_f32 v17, v17, v62
    s_nop 0
    v_add_f32 v17, v17, v63
    v_mfma_f32_32x32x16_bf16 v[64:79], a[60:63], a[28:31], v[64:79]
    ds_read_b64_tr_b16 a[92:93], v13 offset:53248
    ds_read_b64_tr_b16 a[94:95], v13 offset:55296
    v_cvt_pk_bf16_f32 v47, v62, v63
    v_add_u32 v2, 0x10000, v2
    v_add_u32 v3, 0x10000, v3
    v_add_u32 v4, 0x10000, v4
    v_add_u32 v5, 0x10000, v5
    v_add_u32 v6, 0x10000, v6
    v_add_u32 v7, 0x10000, v7
    v_add_u32 v8, 0x10000, v8
    v_add_u32 v9, 0x10000, v9
    s_waitcnt lgkmcnt(0)
    v_mfma_f32_32x32x16_bf16 v[80:95], a[64:67], v[40:43], v[80:95]
    ds_read_b128 a[32:35], v2 offset:0
    ds_read_b128 a[36:39], v3 offset:0
    ds_read_b128 a[40:43], v4 offset:0
    v_mfma_f32_32x32x16_bf16 v[96:111], a[68:71], v[40:43], v[96:111]
    ds_read_b128 a[44:47], v5 offset:0
    ds_read_b128 a[48:51], v6 offset:0
    ds_read_b128 a[52:55], v7 offset:0
    v_mfma_f32_32x32x16_bf16 v[112:127], a[72:75], v[40:43], v[112:127]
    ds_read_b128 a[56:59], v8 offset:0
    ds_read_b128 a[60:63], v9 offset:0
    v_max3_f32 v15, v64, v65, v66
    v_max3_f32 v18, v67, v68, v69
    v_max3_f32 v15, v15, v70, v71
    v_max3_f32 v18, v18, v72, v73
    v_max3_f32 v15, v15, v74, v75
    v_mfma_f32_32x32x16_bf16 v[128:143], a[76:79], v[40:43], v[128:143]
    v_max3_f32 v18, v18, v76, v77
    v_max3_f32 v15, v15, v78, v79
    v_max_f32 v15, v15, v18
    v_mov_b32 v18, v15
    s_nop 1
    v_mfma_f32_32x32x16_bf16 v[80:95], a[80:83], v[44:47], v[80:95]
    v_permlane32_swap_b32 v15, v18
    s_nop 1
    v_max_f32 v15, v15, v18
    v_mul_f32 v15, s66, v15
    v_mfma_f32_32x32x16_bf16 v[96:111], a[84:87], v[44:47], v[96:111]
    v_sub_f32 v18, v15, v16
    v_cmp_lt_f32 vcc, s67, v18
    s_cbranch_vccz L_nors_c26
    v_max_f32 v18, v15, v16
    v_sub_f32 v19, v16, v18
    v_exp_f32 v19, v19
    v_mov_b32 v16, v18
    s_mov_b32 s60, 1
    v_mul_f32 v17, v17, v19
L_nors_c26:
    v_fma_f32 v64, v64, s66, -v16
    v_fma_f32 v65, v65, s66, -v16
    v_fma_f32 v66, v66, s66, -v16
    v_exp_f32 v64, v64
    v_fma_f32 v67, v67, s66, -v16
    v_mfma_f32_32x32x16_bf16 v[112:127], a[88:91], v[44:47], v[112:127]
    v_exp_f32 v65, v65
    v_add_f32 v17, v17, v64
    v_exp_f32 v66, v66
    v_add_f32 v17, v17, v65
    v_cvt_pk_bf16_f32 v144, v64, v65
    v_mfma_f32_32x32x16_bf16 v[128:143], a[92:95], v[44:47], v[128:143]
    v_exp_f32 v67, v67
    v_add_f32 v17, v17, v66
    s_nop 0
    v_add_f32 v17, v17, v67
    v_cvt_pk_bf16_f32 v145, v66, v67
    s_cmp_eq_u32 s60, 0
    s_cbranch_scc1 L_nopend_c27
    s_nop 7
    s_nop 7
    v_mul_f32 v80, v80, v19
    v_mul_f32 v81, v81, v19
    v_mul_f32 v82, v82, v19
    v_mul_f32 v83, v83, v19
    v_mul_f32 v84, v84, v19
    v_mul_f32 v85, v85, v19
    v_mul_f32 v86, v86, v19
    v_mul_f32 v87, v87, v19
    v_mul_f32 v88, v88, v19
    v_mul_f32 v89, v89, v19
    v_mul_f32 v90, v90, v19
    v_mul_f32 v91, v91, v19
    v_mul_f32 v92, v92, v19
    v_mul_f32 v93, v93, v19
    v_mul_f32 v94, v94, v19
    v_mul_f32 v95, v95, v19
    v_mul_f32 v96, v96, v19
    v_mul_f32 v97, v97, v19
    v_mul_f32 v98, v98, v19
    v_mul_f32 v99, v99, v19
    v_mul_f32 v100, v100, v19
    v_mul_f32 v101, v101, v19
    v_mul_f32 v102, v102, v19
    v_mul_f32 v103, v103, v19
    v_mul_f32 v104, v104, v19
    v_mul_f32 v105, v105, v19
    v_mul_f32 v106, v106, v19
    v_mul_f32 v107, v107, v19
    v_mul_f32 v108, v108, v19
    v_mul_f32 v109, v109, v19
    v_mul_f32 v110, v110, v19
    v_mul_f32 v111, v111, v19
    v_mul_f32 v112, v112, v19
    v_mul_f32 v113, v113, v19
    v_mul_f32 v114, v114, v19
    v_mul_f32 v115, v115, v19
    v_mul_f32 v116, v116, v19
    v_mul_f32 v117, v117, v19
    v_mul_f32 v118, v118, v19
    v_mul_f32 v119, v119, v19
    v_mul_f32 v120, v120, v19
    v_mul_f32 v121, v121, v19
    v_mul_f32 v122, v122, v19
    v_mul_f32 v123, v123, v19
    v_mul_f32 v124, v124, v19
    v_mul_f32 v125, v125, v19
    v_mul_f32 v126, v126, v19
    v_mul_f32 v127, v127, v19
    v_mul_f32 v128, v128, v19
    v_mul_f32 v129, v129, v19
    v_mul_f32 v130, v130, v19
    v_mul_f32 v131, v131, v19
    v_mul_f32 v132, v132, v19
    v_mul_f32 v133, v133, v19
    v_mul_f32 v134, v134, v19
    v_mul_f32 v135, v135, v19
    v_mul_f32 v136, v136, v19
    v_mul_f32 v137, v137, v19
    v_mul_f32 v138, v138, v19
    v_mul_f32 v139, v139, v19
    v_mul_f32 v140, v140, v19
    v_mul_f32 v141, v141, v19
    v_mul_f32 v142, v142, v19
    v_mul_f32 v143, v143, v19
    s_mov_b32 s60, 0
    s_nop 1
L_nopend_c27:
    s_waitcnt lgkmcnt(0)
    v_add_u32 v10, 0x10000, v10
    v_add_u32 v11, 0x10000, v11
    v_add_u32 v12, 0x10000, v12
    v_add_u32 v13, 0x10000, v13
    s_mul_i32 s57, s54, 589824
    s_mul_i32 s58, s71, 18432
    s_add_u32 s57, s57, s58
    v_lshlrev_b32 v18, 7, v0
    v_add_u32 v18, s57, v18
    v_cmp_gt_u32 vcc, 144, v0
    s_and_saveexec_b64 s[72:73], vcc
    s_cbranch_execz L_wt_c28
    global_load_dword v34, v18, s[12:13]
L_wt_c28:
    s_mov_b64 exec, s[72:73]
    s_barrier
    v_mfma_f32_32x32x16_bf16 v[48:63], a[32:35], a[0:3], 0
    ds_read_b64_tr_b16 a[64:65], v10 offset:16384
    ds_read_b64_tr_b16 a[66:67], v10 offset:18432
    v_fma_f32 v68, v68, s66, -v16
    v_fma_f32 v69, v69, s66, -v16
    v_fma_f32 v70, v70, s66, -v16
    v_exp_f32 v68, v68
    v_fma_f32 v71, v71, s66, -v16
    v_exp_f32 v69, v69
    v_mfma_f32_32x32x16_bf16 v[48:63], a[36:39], a[4:7], v[48:63]
    ds_read_b64_tr_b16 a[68:69], v11 offset:16384
    ds_read_b64_tr_b16 a[70:71], v11 offset:18432
    v_fma_f32 v72, v72, s66, -v16
    v_add_f32 v17, v17, v68
    v_exp_f32 v70, v70
    v_fma_f32 v73, v73, s66, -v16
    v_add_f32 v17, v17, v69
    v_cvt_pk_bf16_f32 v146, v68, v69
    v_mfma_f32_32x32x16_bf16 v[48:63], a[40:43], a[8:11], v[48:63]
    ds_read_b64_tr_b16 a[72:73], v12 offset:16384
    ds_read_b64_tr_b16 a[74:75], v12 offset:18432
    v_exp_f32 v71, v71
    v_fma_f32 v74, v74, s66, -v16
    v_add_f32 v17, v17, v70
    v_exp_f32 v72, v72
    v_fma_f32 v75, v75, s66, -v16
    v_add_f32 v17, v17, v71
    v_mfma_f32_32x32x16_bf16 v[48:63], a[44:47], a[12:15], v[48:63]
    ds_read_b64_tr_b16 a[76:77], v13 offset:16384
    ds_read_b64_tr_b16 a[78:79], v13 offset:18432
    v_cvt_pk_bf16_f32 v147, v70, v71
    v_exp_f32 v73, v73
    v_fma_f32 v76, v76, s66, -v16
    v_add_f32 v17, v17, v72
    v_exp_f32 v74, v74
    v_fma_f32 v77, v77, s66, -v16
    v_mfma_f32_32x32x16_bf16 v[48:63], a[48:51], a[16:19], v[48:63]
    ds_read_b64_tr_b16 a[80:81], v10 offset:20480
    ds_read_b64_tr_b16 a[82:83], v10 offset:22528
    v_add_f32 v17, v17, v73
    v_cvt_pk_bf16_f32 v148, v72, v73
    v_exp_f32 v75, v75
    v_fma_f32 v78, v78, s66, -v16
    v_add_f32 v17, v17, v74
    v_exp_f32 v76, v76
    v_mfma_f32_32x32x16_bf16 v[48:63], a[52:55], a[20:23], v[48:63]
    ds_read_b64_tr_b16 a[84:85], v11 offset:20480
    ds_read_b64_tr_b16 a[86:87], v11 offset:22528
    v_fma_f32 v79, v79, s66, -v16
    v_add_f32 v17, v17, v75
    v_cvt_pk_bf16_f32 v149, v74, v75
    v_exp_f32 v77, v77
    v_add_f32 v17, v17, v76
    v_exp_f32 v78, v78
    v_mfma_f32_32x32x16_bf16 v[48:63], a[56:59], a[24:27], v[48:63]
    ds_read_b64_tr_b16 a[88:89], v12 offset:20480
    ds_read_b64_tr_b16 a[90:91], v12 offset:22528
    v_add_f32 v17, v17, v77
    v_cvt_pk_bf16_f32 v150, v76, v77
    v_exp_f32 v79, v79
    v_add_f32 v17, v17, v78
    s_nop 0
    v_add_f32 v17, v17, v79
    v_mfma_f32_32x32x16_bf16 v[48:63], a[60:63], a[28:31], v[48:63]
    ds_read_b64_tr_b16 a[92:93], v13 offset:20480
    ds_read_b64_tr_b16 a[94:95], v13 offset:22528
    v_cvt_pk_bf16_f32 v151, v78, v79
    v_subrev_u32 v2, 0x20000, v2
    v_subrev_u32 v3, 0x20000, v3
    v_subrev_u32 v4, 0x20000, v4
    v_subrev_u32 v5, 0x20000, v5
    v_subrev_u32 v6, 0x20000, v6
    v_subrev_u32 v7, 0x20000, v7
    v_subrev_u32 v8, 0x20000, v8
    v_subrev_u32 v9, 0x20000, v9
    s_waitcnt lgkmcnt(0)
    v_mfma_f32_32x32x16_bf16 v[80:95], a[64:67], v[144:147], v[80:95]
    ds_read_b128 a[32:35], v2 offset:0
    ds_read_b128 a[36:39], v3 offset:0
    ds_read_b128 a[40:43], v4 offset:0
    v_mfma_f32_32x32x16_bf16 v[96:111], a[68:71], v[144:147], v[96:111]
    ds_read_b128 a[44:47], v5 offset:0
    ds_read_b128 a[48:51], v6 offset:0
    ds_read_b128 a[52:55], v7 offset:0
    v_mfma_f32_32x32x16_bf16 v[112:127], a[72:75], v[144:147], v[112:127]
    ds_read_b128 a[56:59], v8 offset:0
    ds_read_b128 a[60:63], v9 offset:0
    v_max3_f32 v15, v48, v49, v50
    v_max3_f32 v18, v51, v52, v53
    v_max3_f32 v15, v15, v54, v55
    v_max3_f32 v18, v18, v56, v57
    v_max3_f32 v15, v15, v58, v59
    v_mfma_f32_32x32x16_bf16 v[128:143], a[76:79], v[144:147], v[128:143]
    v_max3_f32 v18, v18, v60, v61
    v_max3_f32 v15, v15, v62, v63
    v_max_f32 v15, v15, v18
    v_mov_b32 v18, v15
    s_nop 1
    v_mfma_f32_32x32x16_bf16 v[80:95], a[80:83], v[148:151], v[80:95]
    v_permlane32_swap_b32 v15, v18
    s_nop 1
    v_max_f32 v15, v15, v18
    v_mul_f32 v15, s66, v15
    v_mfma_f32_32x32x16_bf16 v[96:111], a[84:87], v[148:151], v[96:111]
    v_sub_f32 v18, v15, v16
    v_cmp_lt_f32 vcc, s67, v18
    s_cbranch_vccz L_nors_c29
    v_max_f32 v18, v15, v16
    v_sub_f32 v19, v16, v18
    v_exp_f32 v19, v19
    v_mov_b32 v16, v18
    s_mov_b32 s60, 1
    v_mul_f32 v17, v17, v19
L_nors_c29:
    v_fma_f32 v48, v48, s66, -v16
    v_fma_f32 v49, v49, s66, -v16
    v_fma_f32 v50, v50, s66, -v16
    v_exp_f32 v48, v48
    v_fma_f32 v51, v51, s66, -v16
    v_mfma_f32_32x32x16_bf16 v[112:127], a[88:91], v[148:151], v[112:127]
    v_exp_f32 v49, v49
    v_add_f32 v17, v17, v48
    v_exp_f32 v50, v50
    v_add_f32 v17, v17, v49
    v_cvt_pk_bf16_f32 v40, v48, v49
    v_mfma_f32_32x32x16_bf16 v[128:143], a[92:95], v[148:151], v[128:143]
    v_exp_f32 v51, v51
    v_add_f32 v17, v17, v50
    s_nop 0
    v_add_f32 v17, v17, v51
    v_cvt_pk_bf16_f32 v41, v50, v51
    s_cmp_eq_u32 s60, 0
    s_cbranch_scc1 L_nopend_c30
    s_nop 7
    s_nop 7
    v_mul_f32 v80, v80, v19
    v_mul_f32 v81, v81, v19
    v_mul_f32 v82, v82, v19
    v_mul_f32 v83, v83, v19
    v_mul_f32 v84, v84, v19
    v_mul_f32 v85, v85, v19
    v_mul_f32 v86, v86, v19
    v_mul_f32 v87, v87, v19
    v_mul_f32 v88, v88, v19
    v_mul_f32 v89, v89, v19
    v_mul_f32 v90, v90, v19
    v_mul_f32 v91, v91, v19
    v_mul_f32 v92, v92, v19
    v_mul_f32 v93, v93, v19
    v_mul_f32 v94, v94, v19
    v_mul_f32 v95, v95, v19
    v_mul_f32 v96, v96, v19
    v_mul_f32 v97, v97, v19
    v_mul_f32 v98, v98, v19
    v_mul_f32 v99, v99, v19
    v_mul_f32 v100, v100, v19
    v_mul_f32 v101, v101, v19
    v_mul_f32 v102, v102, v19
    v_mul_f32 v103, v103, v19
    v_mul_f32 v104, v104, v19
    v_mul_f32 v105, v105, v19
    v_mul_f32 v106, v106, v19
    v_mul_f32 v107, v107, v19
    v_mul_f32 v108, v108, v19
    v_mul_f32 v109, v109, v19
    v_mul_f32 v110, v110, v19
    v_mul_f32 v111, v111, v19
    v_mul_f32 v112, v112, v19
    v_mul_f32 v113, v113, v19
    v_mul_f32 v114, v114, v19
    v_mul_f32 v115, v115, v19
    v_mul_f32 v116, v116, v19
    v_mul_f32 v117, v117, v19
    v_mul_f32 v118, v118, v19
    v_mul_f32 v119, v119, v19
    v_mul_f32 v120, v120, v19
    v_mul_f32 v121, v121, v19
    v_mul_f32 v122, v122, v19
    v_mul_f32 v123, v123, v19
    v_mul_f32 v124, v124, v19
    v_mul_f32 v125, v125, v19
    v_mul_f32 v126, v126, v19
    v_mul_f32 v127, v127, v19
    v_mul_f32 v128, v128, v19
    v_mul_f32 v129, v129, v19
    v_mul_f32 v130, v130, v19
    v_mul_f32 v131, v131, v19
    v_mul_f32 v132, v132, v19
    v_mul_f32 v133, v133, v19
    v_mul_f32 v134, v134, v19
    v_mul_f32 v135, v135, v19
    v_mul_f32 v136, v136, v19
    v_mul_f32 v137, v137, v19
    v_mul_f32 v138, v138, v19
    v_mul_f32 v139, v139, v19
    v_mul_f32 v140, v140, v19
    v_mul_f32 v141, v141, v19
    v_mul_f32 v142, v142, v19
    v_mul_f32 v143, v143, v19
    s_mov_b32 s60, 0
    s_nop 1
L_nopend_c30:
    s_waitcnt lgkmcnt(0)
    v_subrev_u32 v10, 0x20000, v10
    v_subrev_u32 v11, 0x20000, v11
    v_subrev_u32 v12, 0x20000, v12
    v_subrev_u32 v13, 0x20000, v13
    s_barrier
    v_mfma_f32_32x32x16_bf16 v[64:79], a[32:35], a[0:3], 0
    ds_read_b64_tr_b16 a[64:65], v10 offset:16384
    ds_read_b64_tr_b16 a[66:67], v10 offset:18432
    v_fma_f32 v52, v52, s66, -v16
    v_fma_f32 v53, v53, s66, -v16
    v_fma_f32 v54, v54, s66, -v16
    v_exp_f32 v52, v52
    v_fma_f32 v55, v55, s66, -v16
    v_exp_f32 v53, v53
    v_mfma_f32_32x32x16_bf16 v[64:79], a[36:39], a[4:7], v[64:79]
    ds_read_b64_tr_b16 a[68:69], v11 offset:16384
    ds_read_b64_tr_b16 a[70:71], v11 offset:18432
    v_fma_f32 v56, v56, s66, -v16
    v_add_f32 v17, v17, v52
    v_exp_f32 v54, v54
    v_fma_f32 v57, v57, s66, -v16
    v_add_f32 v17, v17, v53
    v_cvt_pk_bf16_f32 v42, v52, v53
    v_mfma_f32_32x32x16_bf16 v[64:79], a[40:43], a[8:11], v[64:79]
    ds_read_b64_tr_b16 a[72:73], v12 offset:16384
    ds_read_b64_tr_b16 a[74:75], v12 offset:18432
    v_exp_f32 v55, v55
    v_fma_f32 v58, v58, s66, -v16
    v_add_f32 v17, v17, v54
    v_exp_f32 v56, v56
    v_fma_f32 v59, v59, s66, -v16
    v_add_f32 v17, v17, v55
    v_mfma_f32_32x32x16_bf16 v[64:79], a[44:47], a[12:15], v[64:79]
    ds_read_b64_tr_b16 a[76:77], v13 offset:16384
    ds_read_b64_tr_b16 a[78:79], v13 offset:18432
    v_cvt_pk_bf16_f32 v43, v54, v55
    v_exp_f32 v57, v57
    v_fma_f32 v60, v60, s66, -v16
    v_add_f32 v17, v17, v56
    v_exp_f32 v58, v58
    v_fma_f32 v61, v61, s66, -v16
    v_mfma_f32_32x32x16_bf16 v[64:79], a[48:51], a[16:19], v[64:79]
    ds_read_b64_tr_b16 a[80:81], v10 offset:20480
    ds_read_b64_tr_b16 a[82:83], v10 offset:22528
    v_add_f32 v17, v17, v57
    v_cvt_pk_bf16_f32 v44, v56, v57
    v_exp_f32 v59, v59
    v_fma_f32 v62, v62, s66, -v16
    v_add_f32 v17, v17, v58
    v_exp_f32 v60, v60
    v_mfma_f32_32x32x16_bf16 v[64:79], a[52:55], a[20:23], v[64:79]
    ds_read_b64_tr_b16 a[84:85], v11 offset:20480
    ds_read_b64_tr_b16 a[86:87], v11 offset:22528
    v_fma_f32 v63, v63, s66, -v16
    v_add_f32 v17, v17, v59
    v_cvt_pk_bf16_f32 v45, v58, v59
    v_exp_f32 v61, v61
    v_add_f32 v17, v17, v60
    v_exp_f32 v62, v62
    v_mfma_f32_32x32x16_bf16 v[64:79], a[56:59], a[24:27], v[64:79]
    ds_read_b64_tr_b16 a[88:89], v12 offset:20480
    ds_read_b64_tr_b16 a[90:91], v12 offset:22528
    v_add_f32 v17, v17, v61
    v_cvt_pk_bf16_f32 v46, v60, v61
    v_exp_f32 v63, v63
    v_add_f32 v17, v17, v62
    s_nop 0
    v_add_f32 v17, v17, v63
    v_mfma_f32_32x32x16_bf16 v[64:79], a[60:63], a[28:31], v[64:79]
    ds_read_b64_tr_b16 a[92:93], v13 offset:20480
    ds_read_b64_tr_b16 a[94:95], v13 offset:22528
    v_cvt_pk_bf16_f32 v47, v62, v63
    s_waitcnt lgkmcnt(0)
    v_mfma_f32_32x32x16_bf16 v[80:95], a[64:67], v[40:43], v[80:95]
    ds_read_b128 a[32:35], v2 offset:32768
    ds_read_b128 a[36:39], v3 offset:32768
    ds_read_b128 a[40:43], v4 offset:32768
    v_mfma_f32_32x32x16_bf16 v[96:111], a[68:71], v[40:43], v[96:111]
    ds_read_b128 a[44:47], v5 offset:32768
    ds_read_b128 a[48:51], v6 offset:32768
    ds_read_b128 a[52:55], v7 offset:32768
    v_mfma_f32_32x32x16_bf16 v[112:127], a[72:75], v[40:43], v[112:127]
    ds_read_b128 a[56:59], v8 offset:32768
    ds_read_b128 a[60:63], v9 offset:32768
    v_max3_f32 v15, v64, v65, v66
    v_max3_f32 v18, v67, v68, v69
    v_max3_f32 v15, v15, v70, v71
    v_max3_f32 v18, v18, v72, v73
    v_max3_f32 v15, v15, v74, v75
    v_mfma_f32_32x32x16_bf16 v[128:143], a[76:79], v[40:43], v[128:143]
    v_max3_f32 v18, v18, v76, v77
    v_max3_f32 v15, v15, v78, v79
    v_max_f32 v15, v15, v18
    v_mov_b32 v18, v15
    s_nop 1
    v_mfma_f32_32x32x16_bf16 v[80:95], a[80:83], v[44:47], v[80:95]
    v_permlane32_swap_b32 v15, v18
    s_nop 1
    v_max_f32 v15, v15, v18
    v_mul_f32 v15, s66, v15
    v_mfma_f32_32x32x16_bf16 v[96:111], a[84:87], v[44:47], v[96:111]
    v_sub_f32 v18, v15, v16
    v_cmp_lt_f32 vcc, s67, v18
    s_cbranch_vccz L_nors_c31
    v_max_f32 v18, v15, v16
    v_sub_f32 v19, v16, v18
    v_exp_f32 v19, v19
    v_mov_b32 v16, v18
    s_mov_b32 s60, 1
    v_mul_f32 v17, v17, v19
L_nors_c31:
    v_fma_f32 v64, v64, s66, -v16
    v_fma_f32 v65, v65, s66, -v16
    v_fma_f32 v66, v66, s66, -v16
    v_exp_f32 v64, v64
    v_fma_f32 v67, v67, s66, -v16
    v_mfma_f32_32x32x16_bf16 v[112:127], a[88:91], v[44:47], v[112:127]
    v_exp_f32 v65, v65
    v_add_f32 v17, v17, v64
    v_exp_f32 v66, v66
    v_add_f32 v17, v17, v65
    v_cvt_pk_bf16_f32 v144, v64, v65
    v_mfma_f32_32x32x16_bf16 v[128:143], a[92:95], v[44:47], v[128:143]
    v_exp_f32 v67, v67
    v_add_f32 v17, v17, v66
    s_nop 0
    v_add_f32 v17, v17, v67
    v_cvt_pk_bf16_f32 v145, v66, v67
    s_cmp_eq_u32 s60, 0
    s_cbranch_scc1 L_nopend_c32
    s_nop 7
    s_nop 7
    v_mul_f32 v80, v80, v19
    v_mul_f32 v81, v81, v19
    v_mul_f32 v82, v82, v19
    v_mul_f32 v83, v83, v19
    v_mul_f32 v84, v84, v19
    v_mul_f32 v85, v85, v19
    v_mul_f32 v86, v86, v19
    v_mul_f32 v87, v87, v19
    v_mul_f32 v88, v88, v19
    v_mul_f32 v89, v89, v19
    v_mul_f32 v90, v90, v19
    v_mul_f32 v91, v91, v19
    v_mul_f32 v92, v92, v19
    v_mul_f32 v93, v93, v19
    v_mul_f32 v94, v94, v19
    v_mul_f32 v95, v95, v19
    v_mul_f32 v96, v96, v19
    v_mul_f32 v97, v97, v19
    v_mul_f32 v98, v98, v19
    v_mul_f32 v99, v99, v19
    v_mul_f32 v100, v100, v19
    v_mul_f32 v101, v101, v19
    v_mul_f32 v102, v102, v19
    v_mul_f32 v103, v103, v19
    v_mul_f32 v104, v104, v19
    v_mul_f32 v105, v105, v19
    v_mul_f32 v106, v106, v19
    v_mul_f32 v107, v107, v19
    v_mul_f32 v108, v108, v19
    v_mul_f32 v109, v109, v19
    v_mul_f32 v110, v110, v19
    v_mul_f32 v111, v111, v19
    v_mul_f32 v112, v112, v19
    v_mul_f32 v113, v113, v19
    v_mul_f32 v114, v114, v19
    v_mul_f32 v115, v115, v19
    v_mul_f32 v116, v116, v19
    v_mul_f32 v117, v117, v19
    v_mul_f32 v118, v118, v19
    v_mul_f32 v119, v119, v19
    v_mul_f32 v120, v120, v19
    v_mul_f32 v121, v121, v19
    v_mul_f32 v122, v122, v19
    v_mul_f32 v123, v123, v19
    v_mul_f32 v124, v124, v19
    v_mul_f32 v125, v125, v19
    v_mul_f32 v126, v126, v19
    v_mul_f32 v127, v127, v19
    v_mul_f32 v128, v128, v19
    v_mul_f32 v129, v129, v19
    v_mul_f32 v130, v130, v19
    v_mul_f32 v131, v131, v19
    v_mul_f32 v132, v132, v19
    v_mul_f32 v133, v133, v19
    v_mul_f32 v134, v134, v19
    v_mul_f32 v135, v135, v19
    v_mul_f32 v136, v136, v19
    v_mul_f32 v137, v137, v19
    v_mul_f32 v138, v138, v19
    v_mul_f32 v139, v139, v19
    v_mul_f32 v140, v140, v19
    v_mul_f32 v141, v141, v19
    v_mul_f32 v142, v142, v19
    v_mul_f32 v143, v143, v19
    s_mov_b32 s60, 0
    s_nop 1
L_nopend_c32:
    s_waitcnt lgkmcnt(0)
    s_barrier
    v_mfma_f32_32x32x16_bf16 v[48:63], a[32:35], a[0:3], 0
    ds_read_b64_tr_b16 a[64:65], v10 offset:49152
    ds_read_b64_tr_b16 a[66:67], v10 offset:51200
    v_fma_f32 v68, v68, s66, -v16
    v_fma_f32 v69, v69, s66, -v16
    v_fma_f32 v70, v70, s66, -v16
    v_exp_f32 v68, v68
    v_fma_f32 v71, v71, s66, -v16
    v_exp_f32 v69, v69
    v_mfma_f32_32x32x16_bf16 v[48:63], a[36:39], a[4:7], v[48:63]
    ds_read_b64_tr_b16 a[68:69], v11 offset:49152
    ds_read_b64_tr_b16 a[70:71], v11 offset:51200
    v_fma_f32 v72, v72, s66, -v16
    v_add_f32 v17, v17, v68
    v_exp_f32 v70, v70
    v_fma_f32 v73, v73, s66, -v16
    v_add_f32 v17, v17, v69
    v_cvt_pk_bf16_f32 v146, v68, v69
    v_mfma_f32_32x32x16_bf16 v[48:63], a[40:43], a[8:11], v[48:63]
    ds_read_b64_tr_b16 a[72:73], v12 offset:49152
    ds_read_b64_tr_b16 a[74:75], v12 offset:51200
    v_exp_f32 v71, v71
    v_fma_f32 v74, v74, s66, -v16
    v_add_f32 v17, v17, v70
    v_exp_f32 v72, v72
    v_fma_f32 v75, v75, s66, -v16
    v_add_f32 v17, v17, v71
    v_mfma_f32_32x32x16_bf16 v[48:63], a[44:47], a[12:15], v[48:63]
    ds_read_b64_tr_b16 a[76:77], v13 offset:49152
    ds_read_b64_tr_b16 a[78:79], v13 offset:51200
    v_cvt_pk_bf16_f32 v147, v70, v71
    v_exp_f32 v73, v73
    v_fma_f32 v76, v76, s66, -v16
    v_add_f32 v17, v17, v72
    v_exp_f32 v74, v74
    v_fma_f32 v77, v77, s66, -v16
    v_mfma_f32_32x32x16_bf16 v[48:63], a[48:51], a[16:19], v[48:63]
    ds_read_b64_tr_b16 a[80:81], v10 offset:53248
    ds_read_b64_tr_b16 a[82:83], v10 offset:55296
    v_add_f32 v17, v17, v73
    v_cvt_pk_bf16_f32 v148, v72, v73
    v_exp_f32 v75, v75
    v_fma_f32 v78, v78, s66, -v16
    v_add_f32 v17, v17, v74
    v_exp_f32 v76, v76
    v_mfma_f32_32x32x16_bf16 v[48:63], a[52:55], a[20:23], v[48:63]
    ds_read_b64_tr_b16 a[84:85], v11 offset:53248
    ds_read_b64_tr_b16 a[86:87], v11 offset:55296
    v_fma_f32 v79, v79, s66, -v16
    v_add_f32 v17, v17, v75
    v_cvt_pk_bf16_f32 v149, v74, v75
    v_exp_f32 v77, v77
    v_add_f32 v17, v17, v76
    v_exp_f32 v78, v78
    v_mfma_f32_32x32x16_bf16 v[48:63], a[56:59], a[24:27], v[48:63]
    ds_read_b64_tr_b16 a[88:89], v12 offset:53248
    ds_read_b64_tr_b16 a[90:91], v12 offset:55296
    v_add_f32 v17, v17, v77
    v_cvt_pk_bf16_f32 v150, v76, v77
    v_exp_f32 v79, v79
    v_add_f32 v17, v17, v78
    s_nop 0
    v_add_f32 v17, v17, v79
    v_mfma_f32_32x32x16_bf16 v[48:63], a[60:63], a[28:31], v[48:63]
    ds_read_b64_tr_b16 a[92:93], v13 offset:53248
    ds_read_b64_tr_b16 a[94:95], v13 offset:55296
    v_cvt_pk_bf16_f32 v151, v78, v79
    s_waitcnt lgkmcnt(0)
    v_mfma_f32_32x32x16_bf16 v[80:95], a[64:67], v[144:147], v[80:95]
    v_mfma_f32_32x32x16_bf16 v[96:111], a[68:71], v[144:147], v[96:111]
    v_mfma_f32_32x32x16_bf16 v[112:127], a[72:75], v[144:147], v[112:127]
    s_nop 6
    v_max3_f32 v15, v48, v49, v50
    v_max3_f32 v18, v51, v52, v53
    v_max3_f32 v15, v15, v54, v55
    v_max3_f32 v18, v18, v56, v57
    v_max3_f32 v15, v15, v58, v59
    v_mfma_f32_32x32x16_bf16 v[128:143], a[76:79], v[144:147], v[128:143]
    v_max3_f32 v18, v18, v60, v61
    v_max3_f32 v15, v15, v62, v63
    v_max_f32 v15, v15, v18
    v_mov_b32 v18, v15
    s_nop 1
    v_mfma_f32_32x32x16_bf16 v[80:95], a[80:83], v[148:151], v[80:95]
    v_permlane32_swap_b32 v15, v18
    s_nop 1
    v_max_f32 v15, v15, v18
    v_mul_f32 v15, s66, v15
    v_mfma_f32_32x32x16_bf16 v[96:111], a[84:87], v[148:151], v[96:111]
    v_sub_f32 v18, v15, v16
    v_cmp_lt_f32 vcc, s67, v18
    s_cbranch_vccz L_nors_c33
    v_max_f32 v18, v15, v16
    v_sub_f32 v19, v16, v18
    v_exp_f32 v19, v19
    v_mov_b32 v16, v18
    s_mov_b32 s60, 1
    v_mul_f32 v17, v17, v19
L_nors_c33:
    v_fma_f32 v48, v48, s66, -v16
    v_fma_f32 v49, v49, s66, -v16
    v_fma_f32 v50, v50, s66, -v16
    v_exp_f32 v48, v48
    v_fma_f32 v51, v51, s66, -v16
    v_mfma_f32_32x32x16_bf16 v[112:127], a[88:91], v[148:151], v[112:127]
    v_exp_f32 v49, v49
    v_add_f32 v17, v17, v48
    v_exp_f32 v50, v50
    v_add_f32 v17, v17, v49
    v_cvt_pk_bf16_f32 v40, v48, v49
    v_mfma_f32_32x32x16_bf16 v[128:143], a[92:95], v[148:151], v[128:143]
    v_exp_f32 v51, v51
    v_add_f32 v17, v17, v50
    s_nop 0
    v_add_f32 v17, v17, v51
    v_cvt_pk_bf16_f32 v41, v50, v51
    s_cmp_eq_u32 s60, 0
    s_cbranch_scc1 L_nopend_c34
    s_nop 7
    s_nop 7
    v_mul_f32 v80, v80, v19
    v_mul_f32 v81, v81, v19
    v_mul_f32 v82, v82, v19
    v_mul_f32 v83, v83, v19
    v_mul_f32 v84, v84, v19
    v_mul_f32 v85, v85, v19
    v_mul_f32 v86, v86, v19
    v_mul_f32 v87, v87, v19
    v_mul_f32 v88, v88, v19
    v_mul_f32 v89, v89, v19
    v_mul_f32 v90, v90, v19
    v_mul_f32 v91, v91, v19
    v_mul_f32 v92, v92, v19
    v_mul_f32 v93, v93, v19
    v_mul_f32 v94, v94, v19
    v_mul_f32 v95, v95, v19
    v_mul_f32 v96, v96, v19
    v_mul_f32 v97, v97, v19
    v_mul_f32 v98, v98, v19
    v_mul_f32 v99, v99, v19
    v_mul_f32 v100, v100, v19
    v_mul_f32 v101, v101, v19
    v_mul_f32 v102, v102, v19
    v_mul_f32 v103, v103, v19
    v_mul_f32 v104, v104, v19
    v_mul_f32 v105, v105, v19
    v_mul_f32 v106, v106, v19
    v_mul_f32 v107, v107, v19
    v_mul_f32 v108, v108, v19
    v_mul_f32 v109, v109, v19
    v_mul_f32 v110, v110, v19
    v_mul_f32 v111, v111, v19
    v_mul_f32 v112, v112, v19
    v_mul_f32 v113, v113, v19
    v_mul_f32 v114, v114, v19
    v_mul_f32 v115, v115, v19
    v_mul_f32 v116, v116, v19
    v_mul_f32 v117, v117, v19
    v_mul_f32 v118, v118, v19
    v_mul_f32 v119, v119, v19
    v_mul_f32 v120, v120, v19
    v_mul_f32 v121, v121, v19
    v_mul_f32 v122, v122, v19
    v_mul_f32 v123, v123, v19
    v_mul_f32 v124, v124, v19
    v_mul_f32 v125, v125, v19
    v_mul_f32 v126, v126, v19
    v_mul_f32 v127, v127, v19
    v_mul_f32 v128, v128, v19
    v_mul_f32 v129, v129, v19
    v_mul_f32 v130, v130, v19
    v_mul_f32 v131, v131, v19
    v_mul_f32 v132, v132, v19
    v_mul_f32 v133, v133, v19
    v_mul_f32 v134, v134, v19
    v_mul_f32 v135, v135, v19
    v_mul_f32 v136, v136, v19
    v_mul_f32 v137, v137, v19
    v_mul_f32 v138, v138, v19
    v_mul_f32 v139, v139, v19
    v_mul_f32 v140, v140, v19
    v_mul_f32 v141, v141, v19
    v_mul_f32 v142, v142, v19
    v_mul_f32 v143, v143, v19
    s_mov_b32 s60, 0
    s_nop 1
L_nopend_c34:
    v_mov_b32 v18, 162816
    ds_read_b64 v[20:21], v18
    s_waitcnt lgkmcnt(0)
    v_readfirstlane_b32 s62, v20
    v_readfirstlane_b32 s61, v21
    s_waitcnt lgkmcnt(0)
    v_add_u32 v10, 0x10000, v10
    v_add_u32 v11, 0x10000, v11
    v_add_u32 v12, 0x10000, v12
    v_add_u32 v13, 0x10000, v13
    v_add_u32 v2, 0x10000, v2
    v_add_u32 v3, 0x10000, v3
    v_add_u32 v4, 0x10000, v4
    v_add_u32 v5, 0x10000, v5
    v_add_u32 v6, 0x10000, v6
    v_add_u32 v7, 0x10000, v7
    v_add_u32 v8, 0x10000, v8
    v_add_u32 v9, 0x10000, v9
    s_barrier
    ds_read_b128 a[32:35], v2 offset:0
    ds_read_b128 a[36:39], v3 offset:0
    ds_read_b128 a[40:43], v4 offset:0
    ds_read_b128 a[44:47], v5 offset:0
    ds_read_b128 a[48:51], v6 offset:0
    ds_read_b128 a[52:55], v7 offset:0
    ds_read_b128 a[56:59], v8 offset:0
    ds_read_b128 a[60:63], v9 offset:0
    v_fma_f32 v52, v52, s66, -v16
    v_fma_f32 v53, v53, s66, -v16
    v_fma_f32 v54, v54, s66, -v16
    v_exp_f32 v52, v52
    v_fma_f32 v55, v55, s66, -v16
    v_exp_f32 v53, v53
    v_fma_f32 v56, v56, s66, -v16
    v_add_f32 v17, v17, v52
    v_exp_f32 v54, v54
    v_fma_f32 v57, v57, s66, -v16
    v_add_f32 v17, v17, v53
    v_cvt_pk_bf16_f32 v42, v52, v53
    s_waitcnt lgkmcnt(7)
    v_mfma_f32_32x32x16_bf16 v[64:79], a[32:35], a[0:3], 0
    v_exp_f32 v55, v55
    v_fma_f32 v58, v58, s66, -v16
    v_add_f32 v17, v17, v54
    v_exp_f32 v56, v56
    s_waitcnt lgkmcnt(6)
    v_mfma_f32_32x32x16_bf16 v[64:79], a[36:39], a[4:7], v[64:79]
    v_fma_f32 v59, v59, s66, -v16
    v_add_f32 v17, v17, v55
    v_cvt_pk_bf16_f32 v43, v54, v55
    v_exp_f32 v57, v57
    s_waitcnt lgkmcnt(5)
    v_mfma_f32_32x32x16_bf16 v[64:79], a[40:43], a[8:11], v[64:79]
    v_fma_f32 v60, v60, s66, -v16
    v_add_f32 v17, v17, v56
    v_exp_f32 v58, v58
    v_fma_f32 v61, v61, s66, -v16
    s_waitcnt lgkmcnt(4)
    v_mfma_f32_32x32x16_bf16 v[64:79], a[44:47], a[12:15], v[64:79]
    v_add_f32 v17, v17, v57
    v_cvt_pk_bf16_f32 v44, v56, v57
    v_exp_f32 v59, v59
    v_fma_f32 v62, v62, s66, -v16
    s_waitcnt lgkmcnt(3)
    v_mfma_f32_32x32x16_bf16 v[64:79], a[48:51], a[16:19], v[64:79]
    v_add_f32 v17, v17, v58
    v_exp_f32 v60, v60
    v_fma_f32 v63, v63, s66, -v16
    v_add_f32 v17, v17, v59
    s_waitcnt lgkmcnt(2)
    v_mfma_f32_32x32x16_bf16 v[64:79], a[52:55], a[20:23], v[64:79]
    v_cvt_pk_bf16_f32 v45, v58, v59
    v_exp_f32 v61, v61
    v_add_f32 v17, v17, v60
    v_exp_f32 v62, v62
    s_waitcnt lgkmcnt(1)
    v_mfma_f32_32x32x16_bf16 v[64:79], a[56:59], a[24:27], v[64:79]
    v_add_f32 v17, v17, v61
    v_cvt_pk_bf16_f32 v46, v60, v61
    v_exp_f32 v63, v63
    v_add_f32 v17, v17, v62
    s_waitcnt lgkmcnt(0)
    v_mfma_f32_32x32x16_bf16 v[64:79], a[60:63], a[28:31], v[64:79]
    s_nop 0
    v_add_f32 v17, v17, v63
    v_cvt_pk_bf16_f32 v47, v62, v63
    s_nop 7
    s_nop 3
    v_max3_f32 v15, v64, v65, v66
    v_max3_f32 v18, v67, v68, v69
    v_max3_f32 v15, v15, v70, v71
    v_max3_f32 v18, v18, v72, v73
    v_max3_f32 v15, v15, v74, v75
    v_max3_f32 v18, v18, v76, v77
    v_max3_f32 v15, v15, v78, v79
    v_max_f32 v15, v15, v18
    v_mov_b32 v18, v15
    s_nop 1
    v_permlane32_swap_b32 v15, v18
    s_nop 1
    v_max_f32 v15, v15, v18
    v_mul_f32 v15, s66, v15
    v_sub_f32 v18, v15, v16
    v_cmp_lt_f32 vcc, s67, v18
    s_cbranch_vccz L_nors_c35
    v_max_f32 v18, v15, v16
    v_sub_f32 v19, v16, v18
    v_exp_f32 v19, v19
    v_mov_b32 v16, v18
    s_mov_b32 s60, 1
    v_mul_f32 v17, v17, v19
L_nors_c35:
    s_barrier
    ds_read_b64_tr_b16 a[64:65], v10 offset:16384
    ds_read_b64_tr_b16 a[66:67], v10 offset:18432
    ds_read_b64_tr_b16 a[68:69], v11 offset:16384
    ds_read_b64_tr_b16 a[70:71], v11 offset:18432
    ds_read_b64_tr_b16 a[72:73], v12 offset:16384
    ds_read_b64_tr_b16 a[74:75], v12 offset:18432
    ds_read_b64_tr_b16 a[76:77], v13 offset:16384
    ds_read_b64_tr_b16 a[78:79], v13 offset:18432
    ds_read_b64_tr_b16 a[80:81], v10 offset:20480
    ds_read_b64_tr_b16 a[82:83], v10 offset:22528
    ds_read_b64_tr_b16 a[84:85], v11 offset:20480
    ds_read_b64_tr_b16 a[86:87], v11 offset:22528
    ds_read_b64_tr_b16 a[88:89], v12 offset:20480
    ds_read_b64_tr_b16 a[90:91], v12 offset:22528
    ds_read_b64_tr_b16 a[92:93], v13 offset:20480
    ds_read_b64_tr_b16 a[94:95], v13 offset:22528
    v_fma_f32 v64, v64, s66, -v16
    v_fma_f32 v65, v65, s66, -v16
    v_fma_f32 v66, v66, s66, -v16
    v_exp_f32 v64, v64
    v_fma_f32 v67, v67, s66, -v16
    v_exp_f32 v65, v65
    v_fma_f32 v68, v68, s66, -v16
    v_add_f32 v17, v17, v64
    v_exp_f32 v66, v66
    v_fma_f32 v69, v69, s66, -v16
    v_add_f32 v17, v17, v65
    v_cvt_pk_bf16_f32 v144, v64, v65
    v_exp_f32 v67, v67
    v_fma_f32 v70, v70, s66, -v16
    s_waitcnt lgkmcnt(14)
    v_mfma_f32_32x32x16_bf16 v[80:95], a[64:67], v[40:43], v[80:95]
    v_add_f32 v17, v17, v66
    v_exp_f32 v68, v68
    v_fma_f32 v71, v71, s66, -v16
    v_add_f32 v17, v17, v67
    v_cvt_pk_bf16_f32 v145, v66, v67
    v_exp_f32 v69, v69
    s_waitcnt lgkmcnt(12)
    v_mfma_f32_32x32x16_bf16 v[96:111], a[68:71], v[40:43], v[96:111]
    v_fma_f32 v72, v72, s66, -v16
    v_add_f32 v17, v17, v68
    v_exp_f32 v70, v70
    v_fma_f32 v73, v73, s66, -v16
    v_add_f32 v17, v17, v69
    v_cvt_pk_bf16_f32 v146, v68, v69
    s_waitcnt lgkmcnt(10)
    v_mfma_f32_32x32x16_bf16 v[112:127], a[72:75], v[40:43], v[112:127]
    v_exp_f32 v71, v71
    v_fma_f32 v74, v74, s66, -v16
    v_add_f32 v17, v17, v70
    v_exp_f32 v72, v72
    v_fma_f32 v75, v75, s66, -v16
    v_add_f32 v17, v17, v71
    s_waitcnt lgkmcnt(8)
    v_mfma_f32_32x32x16_bf16 v[128:143], a[76:79], v[40:43], v[128:143]
    v_cvt_pk_bf16_f32 v147, v70, v71
    v_exp_f32 v73, v73
    v_fma_f32 v76, v76, s66, -v16
    v_add_f32 v17, v17, v72
    v_exp_f32 v74, v74
    v_fma_f32 v77, v77, s66, -v16
    s_waitcnt lgkmcnt(6)
    v_mfma_f32_32x32x16_bf16 v[80:95], a[80:83], v[44:47], v[80:95]
    v_add_f32 v17, v17, v73
    v_cvt_pk_bf16_f32 v148, v72, v73
    v_exp_f32 v75, v75
    v_fma_f32 v78, v78, s66, -v16
    v_add_f32 v17, v17, v74
    v_exp_f32 v76, v76
    s_waitcnt lgkmcnt(4)
    v_mfma_f32_32x32x16_bf16 v[96:111], a[84:87], v[44:47], v[96:111]
    v_fma_f32 v79, v79, s66, -v16
    v_add_f32 v17, v17, v75
    v_cvt_pk_bf16_f32 v149, v74, v75
    v_exp_f32 v77, v77
    v_add_f32 v17, v17, v76
    v_exp_f32 v78, v78
    s_waitcnt lgkmcnt(2)
    v_mfma_f32_32x32x16_bf16 v[112:127], a[88:91], v[44:47], v[112:127]
    v_add_f32 v17, v17, v77
    v_cvt_pk_bf16_f32 v150, v76, v77
    v_exp_f32 v79, v79
    v_add_f32 v17, v17, v78
    s_nop 0
    v_add_f32 v17, v17, v79
    s_waitcnt lgkmcnt(0)
    v_mfma_f32_32x32x16_bf16 v[128:143], a[92:95], v[44:47], v[128:143]
    v_cvt_pk_bf16_f32 v151, v78, v79
    s_cmp_eq_u32 s60, 0
    s_cbranch_scc1 L_nopend_c36
    s_nop 7
    s_nop 7
    v_mul_f32 v80, v80, v19
    v_mul_f32 v81, v81, v19
    v_mul_f32 v82, v82, v19
    v_mul_f32 v83, v83, v19
    v_mul_f32 v84, v84, v19
    v_mul_f32 v85, v85, v19
    v_mul_f32 v86, v86, v19
    v_mul_f32 v87, v87, v19
    v_mul_f32 v88, v88, v19
    v_mul_f32 v89, v89, v19
    v_mul_f32 v90, v90, v19
    v_mul_f32 v91, v91, v19
    v_mul_f32 v92, v92, v19
    v_mul_f32 v93, v93, v19
    v_mul_f32 v94, v94, v19
    v_mul_f32 v95, v95, v19
    v_mul_f32 v96, v96, v19
    v_mul_f32 v97, v97, v19
    v_mul_f32 v98, v98, v19
    v_mul_f32 v99, v99, v19
    v_mul_f32 v100, v100, v19
    v_mul_f32 v101, v101, v19
    v_mul_f32 v102, v102, v19
    v_mul_f32 v103, v103, v19
    v_mul_f32 v104, v104, v19
    v_mul_f32 v105, v105, v19
    v_mul_f32 v106, v106, v19
    v_mul_f32 v107, v107, v19
    v_mul_f32 v108, v108, v19
    v_mul_f32 v109, v109, v19
    v_mul_f32 v110, v110, v19
    v_mul_f32 v111, v111, v19
    v_mul_f32 v112, v112, v19
    v_mul_f32 v113, v113, v19
    v_mul_f32 v114, v114, v19
    v_mul_f32 v115, v115, v19
    v_mul_f32 v116, v116, v19
    v_mul_f32 v117, v117, v19
    v_mul_f32 v118, v118, v19
    v_mul_f32 v119, v119, v19
    v_mul_f32 v120, v120, v19
    v_mul_f32 v121, v121, v19
    v_mul_f32 v122, v122, v19
    v_mul_f32 v123, v123, v19
    v_mul_f32 v124, v124, v19
    v_mul_f32 v125, v125, v19
    v_mul_f32 v126, v126, v19
    v_mul_f32 v127, v127, v19
    v_mul_f32 v128, v128, v19
    v_mul_f32 v129, v129, v19
    v_mul_f32 v130, v130, v19
    v_mul_f32 v131, v131, v19
    v_mul_f32 v132, v132, v19
    v_mul_f32 v133, v133, v19
    v_mul_f32 v134, v134, v19
    v_mul_f32 v135, v135, v19
    v_mul_f32 v136, v136, v19
    v_mul_f32 v137, v137, v19
    v_mul_f32 v138, v138, v19
    v_mul_f32 v139, v139, v19
    v_mul_f32 v140, v140, v19
    v_mul_f32 v141, v141, v19
    v_mul_f32 v142, v142, v19
    v_mul_f32 v143, v143, v19
    s_mov_b32 s60, 0
    s_nop 1
L_nopend_c36:
    v_mov_b32 v21, v17
    v_mov_b32 v20, v16
    s_nop 0
    v_permlane32_swap_b32 v17, v21
    s_nop 1
    v_add_f32 v17, v17, v21
    v_mov_b32 v21, v17
    ds_write_b64 v35, v[20:21]
    s_waitcnt lgkmcnt(0)
    s_barrier
    ds_read_b64 v[20:21], v36
    ds_read_b64_tr_b16 a[72:73], v12 offset:32768
    ds_read_b64_tr_b16 a[74:75], v12 offset:34816
    ds_read_b64_tr_b16 a[76:77], v13 offset:32768
    ds_read_b64_tr_b16 a[78:79], v13 offset:34816
    ds_read_b64_tr_b16 a[64:65], v10 offset:32768
    ds_read_b64_tr_b16 a[66:67], v10 offset:34816
    ds_read_b64_tr_b16 a[68:69], v11 offset:32768
    ds_read_b64_tr_b16 a[70:71], v11 offset:34816
    ds_read_b64_tr_b16 a[88:89], v12 offset:36864
    ds_read_b64_tr_b16 a[90:91], v12 offset:38912
    ds_read_b64_tr_b16 a[92:93], v13 offset:36864
    ds_read_b64_tr_b16 a[94:95], v13 offset:38912
    ds_read_b64_tr_b16 a[80:81], v10 offset:36864
    ds_read_b64_tr_b16 a[82:83], v10 offset:38912
    ds_read_b64_tr_b16 a[84:85], v11 offset:36864
    ds_read_b64_tr_b16 a[86:87], v11 offset:38912
    s_waitcnt lgkmcnt(15)
    v_max_f32 v22, v16, v20
    v_sub_f32 v24, v16, v22
    v_sub_f32 v26, v20, v22
    v_exp_f32 v24, v24
    v_exp_f32 v26, v26
    s_nop 0
    v_mul_f32 v23, v24, v17
    v_fma_f32 v23, v26, v21, v23
    v_rcp_f32 v23, v23
    s_nop 0
    v_mul_f32 v24, v24, v23
    v_mul_f32 v26, v26, v23
    v_mov_b32 v25, v24
    v_mov_b32 v27, v26
    s_waitcnt lgkmcnt(14)
    v_mfma_f32_32x32x16_bf16 v[112:127], a[72:75], v[144:147], v[112:127]
    s_waitcnt lgkmcnt(12)
    v_mfma_f32_32x32x16_bf16 v[128:143], a[76:79], v[144:147], v[128:143]
    s_waitcnt lgkmcnt(10)
    v_mfma_f32_32x32x16_bf16 v[80:95], a[64:67], v[144:147], v[80:95]
    s_waitcnt lgkmcnt(8)
    v_mfma_f32_32x32x16_bf16 v[96:111], a[68:71], v[144:147], v[96:111]
    s_waitcnt lgkmcnt(6)
    v_mfma_f32_32x32x16_bf16 v[112:127], a[88:91], v[148:151], v[112:127]
    s_waitcnt lgkmcnt(4)
    v_mfma_f32_32x32x16_bf16 v[128:143], a[92:95], v[148:151], v[128:143]
    s_waitcnt lgkmcnt(2)
    v_mfma_f32_32x32x16_bf16 v[80:95], a[80:83], v[148:151], v[80:95]
    s_waitcnt lgkmcnt(0)
    v_mfma_f32_32x32x16_bf16 v[96:111], a[84:87], v[148:151], v[96:111]
    v_lshrrev_b32 v22, 4, v1
    v_lshrrev_b32 v23, 1, v22
    v_lshlrev_b32 v23, 4, v23
    v_and_b32 v28, 1, v22
    v_lshl_add_u32 v23, v28, 2, v23
    v_and_b32 v28, 15, v1
    v_lshrrev_b32 v28, 2, v28
    v_add_u32 v23, v23, v28
    v_mul_u32_u24 v23, 288, v23
    v_and_b32 v28, 3, v1
    v_lshl_add_u32 v30, v28, 3, v23
    v_add_u32 v31, 0x10000, v30
    v_add_u32 v32, 0x20000, v30
    ds_write_b128 v37, v[112:115] offset:0
    ds_write_b128 v37, v[116:119] offset:1024
    ds_write_b128 v37, v[120:123] offset:2048
    ds_write_b128 v37, v[124:127] offset:3072
    ds_write_b128 v37, v[128:131] offset:4096
    ds_write_b128 v37, v[132:135] offset:5120
    ds_write_b128 v37, v[136:139] offset:6144
    ds_write_b128 v37, v[140:143] offset:7168
    v_pk_mul_f32 v[80:81], v[80:81], v[24:25]
    v_pk_mul_f32 v[82:83], v[82:83], v[24:25]
    v_pk_mul_f32 v[84:85], v[84:85], v[24:25]
    v_pk_mul_f32 v[86:87], v[86:87], v[24:25]
    v_pk_mul_f32 v[88:89], v[88:89], v[24:25]
    v_pk_mul_f32 v[90:91], v[90:91], v[24:25]
    v_pk_mul_f32 v[92:93], v[92:93], v[24:25]
    v_pk_mul_f32 v[94:95], v[94:95], v[24:25]
    v_pk_mul_f32 v[96:97], v[96:97], v[24:25]
    v_pk_mul_f32 v[98:99], v[98:99], v[24:25]
    v_pk_mul_f32 v[100:101], v[100:101], v[24:25]
    v_pk_mul_f32 v[102:103], v[102:103], v[24:25]
    v_pk_mul_f32 v[104:105], v[104:105], v[24:25]
    v_pk_mul_f32 v[106:107], v[106:107], v[24:25]
    v_pk_mul_f32 v[108:109], v[108:109], v[24:25]
    v_pk_mul_f32 v[110:111], v[110:111], v[24:25]
    s_waitcnt lgkmcnt(0)
    s_barrier
    ds_read_b128 v[112:115], v38 offset:0
    ds_read_b128 v[116:119], v38 offset:1024
    ds_read_b128 v[120:123], v38 offset:2048
    ds_read_b128 v[124:127], v38 offset:3072
    ds_read_b128 v[128:131], v38 offset:4096
    ds_read_b128 v[132:135], v38 offset:5120
    ds_read_b128 v[136:139], v38 offset:6144
    ds_read_b128 v[140:143], v38 offset:7168
    s_cmp_eq_u32 s62, 0
    s_cbranch_scc1 L_oslow_c37
    s_waitcnt lgkmcnt(7)
    v_pk_fma_f32 v[80:81], v[112:113], v[26:27], v[80:81]
    v_pk_fma_f32 v[82:83], v[114:115], v[26:27], v[82:83]
    v_cvt_pk_bf16_f32 v48, v80, v81
    v_cvt_pk_bf16_f32 v49, v82, v83
    s_waitcnt lgkmcnt(6)
    v_pk_fma_f32 v[84:85], v[116:117], v[26:27], v[84:85]
    v_pk_fma_f32 v[86:87], v[118:119], v[26:27], v[86:87]
    v_cvt_pk_bf16_f32 v50, v84, v85
    v_cvt_pk_bf16_f32 v51, v86, v87
    buffer_store_dwordx4 v[48:51], v39, s[40:43], 0 offen offset:0
    s_waitcnt lgkmcnt(5)
    v_pk_fma_f32 v[88:89], v[120:121], v[26:27], v[88:89]
    v_pk_fma_f32 v[90:91], v[122:123], v[26:27], v[90:91]
    v_cvt_pk_bf16_f32 v52, v88, v89
    v_cvt_pk_bf16_f32 v53, v90, v91
    s_waitcnt lgkmcnt(4)
    v_pk_fma_f32 v[92:93], v[124:125], v[26:27], v[92:93]
    v_pk_fma_f32 v[94:95], v[126:127], v[26:27], v[94:95]
    v_cvt_pk_bf16_f32 v54, v92, v93
    v_cvt_pk_bf16_f32 v55, v94, v95
    buffer_store_dwordx4 v[52:55], v39, s[40:43], 0 offen offset:512
    s_waitcnt lgkmcnt(3)
    v_pk_fma_f32 v[96:97], v[128:129], v[26:27], v[96:97]
    v_pk_fma_f32 v[98:99], v[130:131], v[26:27], v[98:99]
    v_cvt_pk_bf16_f32 v56, v96, v97
    v_cvt_pk_bf16_f32 v57, v98, v99
    s_waitcnt lgkmcnt(2)
    v_pk_fma_f32 v[100:101], v[132:133], v[26:27], v[100:101]
    v_pk_fma_f32 v[102:103], v[134:135], v[26:27], v[102:103]
    v_cvt_pk_bf16_f32 v58, v100, v101
    v_cvt_pk_bf16_f32 v59, v102, v103
    buffer_store_dwordx4 v[56:59], v39, s[40:43], 0 offen offset:1024
    s_waitcnt lgkmcnt(1)
    v_pk_fma_f32 v[104:105], v[136:137], v[26:27], v[104:105]
    v_pk_fma_f32 v[106:107], v[138:139], v[26:27], v[106:107]
    v_cvt_pk_bf16_f32 v60, v104, v105
    v_cvt_pk_bf16_f32 v61, v106, v107
    s_waitcnt lgkmcnt(0)
    v_pk_fma_f32 v[108:109], v[140:141], v[26:27], v[108:109]
    v_pk_fma_f32 v[110:111], v[142:143], v[26:27], v[110:111]
    v_cvt_pk_bf16_f32 v62, v108, v109
    v_cvt_pk_bf16_f32 v63, v110, v111
    buffer_store_dwordx4 v[60:63], v39, s[40:43], 0 offen offset:1536
    s_branch L_ojoin_c38
L_oslow_c37:
    s_waitcnt lgkmcnt(7)
    v_pk_fma_f32 v[80:81], v[112:113], v[26:27], v[80:81]
    v_pk_fma_f32 v[82:83], v[114:115], v[26:27], v[82:83]
    v_cvt_pk_bf16_f32 v48, v80, v81
    v_cvt_pk_bf16_f32 v49, v82, v83
    s_waitcnt lgkmcnt(6)
    v_pk_fma_f32 v[84:85], v[116:117], v[26:27], v[84:85]
    v_pk_fma_f32 v[86:87], v[118:119], v[26:27], v[86:87]
    v_cvt_pk_bf16_f32 v50, v84, v85
    v_cvt_pk_bf16_f32 v51, v86, v87
    buffer_store_dwordx4 v[48:51], v39, s[40:43], 0 offen offset:0 sc1
    s_waitcnt lgkmcnt(5)
    v_pk_fma_f32 v[88:89], v[120:121], v[26:27], v[88:89]
    v_pk_fma_f32 v[90:91], v[122:123], v[26:27], v[90:91]
    v_cvt_pk_bf16_f32 v52, v88, v89
    v_cvt_pk_bf16_f32 v53, v90, v91
    s_waitcnt lgkmcnt(4)
    v_pk_fma_f32 v[92:93], v[124:125], v[26:27], v[92:93]
    v_pk_fma_f32 v[94:95], v[126:127], v[26:27], v[94:95]
    v_cvt_pk_bf16_f32 v54, v92, v93
    v_cvt_pk_bf16_f32 v55, v94, v95
    buffer_store_dwordx4 v[52:55], v39, s[40:43], 0 offen offset:512 sc1
    s_waitcnt lgkmcnt(3)
    v_pk_fma_f32 v[96:97], v[128:129], v[26:27], v[96:97]
    v_pk_fma_f32 v[98:99], v[130:131], v[26:27], v[98:99]
    v_cvt_pk_bf16_f32 v56, v96, v97
    v_cvt_pk_bf16_f32 v57, v98, v99
    s_waitcnt lgkmcnt(2)
    v_pk_fma_f32 v[100:101], v[132:133], v[26:27], v[100:101]
    v_pk_fma_f32 v[102:103], v[134:135], v[26:27], v[102:103]
    v_cvt_pk_bf16_f32 v58, v100, v101
    v_cvt_pk_bf16_f32 v59, v102, v103
    buffer_store_dwordx4 v[56:59], v39, s[40:43], 0 offen offset:1024 sc1
    s_waitcnt lgkmcnt(1)
    v_pk_fma_f32 v[104:105], v[136:137], v[26:27], v[104:105]
    v_pk_fma_f32 v[106:107], v[138:139], v[26:27], v[106:107]
    v_cvt_pk_bf16_f32 v60, v104, v105
    v_cvt_pk_bf16_f32 v61, v106, v107
    s_waitcnt lgkmcnt(0)
    v_pk_fma_f32 v[108:109], v[140:141], v[26:27], v[108:109]
    v_pk_fma_f32 v[110:111], v[142:143], v[26:27], v[110:111]
    v_cvt_pk_bf16_f32 v62, v108, v109
    v_cvt_pk_bf16_f32 v63, v110, v111
    buffer_store_dwordx4 v[60:63], v39, s[40:43], 0 offen offset:1536 sc1
L_ojoin_c38:
    s_barrier
    s_and_b32 s57, s56, 0xfc
    s_lshl_b32 s57, s57, 14
    s_add_u32 s57, s57, s63
    s_add_u32 s57, s57, 1048576
    s_lshl_b32 s58, s55, 14
    s_add_u32 s58, s58, s57
    s_waitcnt vmcnt(0)
    s_barrier
    buffer_load_dwordx4 a[0:3], v14, s[40:43], s58 offen offset:0 sc1
    buffer_load_dwordx4 a[4:7], v14, s[40:43], s58 offen offset:1024 sc1
    buffer_load_dwordx4 a[8:11], v14, s[40:43], s58 offen offset:2048 sc1
    buffer_load_dwordx4 a[12:15], v14, s[40:43], s58 offen offset:3072 sc1
    ds_read_b64_tr_b16 a[64:65], v31 offset:49152
    ds_read_b64_tr_b16 a[66:67], v31 offset:51456
    ds_read_b64_tr_b16 a[68:69], v31 offset:49184
    ds_read_b64_tr_b16 a[70:71], v31 offset:51488
    ds_read_b64_tr_b16 a[72:73], v31 offset:49216
    ds_read_b64_tr_b16 a[74:75], v31 offset:51520
    ds_read_b64_tr_b16 a[76:77], v31 offset:49248
    ds_read_b64_tr_b16 a[78:79], v31 offset:51552
    ds_read_b64_tr_b16 a[80:81], v31 offset:49280
    ds_read_b64_tr_b16 a[82:83], v31 offset:51584
    ds_read_b64_tr_b16 a[84:85], v31 offset:49312
    ds_read_b64_tr_b16 a[86:87], v31 offset:51616
    ds_read_b64_tr_b16 a[88:89], v31 offset:49344
    ds_read_b64_tr_b16 a[90:91], v31 offset:51648
    s_lshl_b32 s59, s53, 2
    s_add_u32 s59, s59, s55
    s_lshl_b32 s59, s59, 3
    s_add_u32 s59, s59, s54
    s_mul_i32 s59, s59, 20480
    s_mul_i32 s64, s52, 5120
    s_add_u32 s59, s59, s64
    s_add_u32 s59, s59, 8388608
    v_mov_b32 v134, 0
    v_mov_b32 v135, 0
    s_waitcnt vmcnt(3)
    s_waitcnt lgkmcnt(6)
    v_mfma_f32_16x16x32_bf16 v[80:83], a[64:67], a[0:3], 0
    ds_read_b64_tr_b16 a[92:93], v31 offset:49376
    ds_read_b64_tr_b16 a[94:95], v31 offset:51680
    v_mfma_f32_16x16x32_bf16 v[84:87], a[68:71], a[0:3], 0
    ds_read_b64_tr_b16 a[96:97], v31 offset:49408
    ds_read_b64_tr_b16 a[98:99], v31 offset:51712
    v_mfma_f32_16x16x32_bf16 v[88:91], a[72:75], a[0:3], 0
    ds_read_b64_tr_b16 a[100:101], v31 offset:58368
    ds_read_b64_tr_b16 a[102:103], v31 offset:60672
    v_mfma_f32_16x16x32_bf16 v[92:95], a[76:79], a[0:3], 0
    ds_read_b64_tr_b16 a[64:65], v31 offset:58400
    ds_read_b64_tr_b16 a[66:67], v31 offset:60704
    s_waitcnt lgkmcnt(6)
    v_mfma_f32_16x16x32_bf16 v[96:99], a[80:83], a[0:3], 0
    ds_read_b64_tr_b16 a[68:69], v31 offset:58432
    ds_read_b64_tr_b16 a[70:71], v31 offset:60736
    v_mfma_f32_16x16x32_bf16 v[100:103], a[84:87], a[0:3], 0
    ds_read_b64_tr_b16 a[72:73], v31 offset:58464
    ds_read_b64_tr_b16 a[74:75], v31 offset:60768
    v_mfma_f32_16x16x32_bf16 v[104:107], a[88:91], a[0:3], 0
    ds_read_b64_tr_b16 a[76:77], v31 offset:58496
    ds_read_b64_tr_b16 a[78:79], v31 offset:60800
    v_mfma_f32_16x16x32_bf16 v[108:111], a[92:95], a[0:3], 0
    ds_read_b64_tr_b16 a[80:81], v31 offset:58528
    ds_read_b64_tr_b16 a[82:83], v31 offset:60832
    s_waitcnt lgkmcnt(6)
    v_mfma_f32_16x16x32_bf16 v[112:115], a[96:99], a[0:3], 0
    ds_read_b64_tr_b16 a[84:85], v31 offset:58560
    ds_read_b64_tr_b16 a[86:87], v31 offset:60864
    s_waitcnt vmcnt(2)
    v_mfma_f32_16x16x32_bf16 v[80:83], a[100:103], a[4:7], v[80:83]
    ds_read_b64_tr_b16 a[88:89], v31 offset:58592
    ds_read_b64_tr_b16 a[90:91], v31 offset:60896
    v_mfma_f32_16x16x32_bf16 v[84:87], a[64:67], a[4:7], v[84:87]
    ds_read_b64_tr_b16 a[92:93], v31 offset:58624
    ds_read_b64_tr_b16 a[94:95], v31 offset:60928
    v_mfma_f32_16x16x32_bf16 v[88:91], a[68:71], a[4:7], v[88:91]
    ds_read_b64_tr_b16 a[96:97], v32 offset:2048
    ds_read_b64_tr_b16 a[98:99], v32 offset:4352
    s_waitcnt lgkmcnt(6)
    v_mfma_f32_16x16x32_bf16 v[92:95], a[72:75], a[4:7], v[92:95]
    ds_read_b64_tr_b16 a[100:101], v32 offset:2080
    ds_read_b64_tr_b16 a[102:103], v32 offset:4384
    v_mfma_f32_16x16x32_bf16 v[96:99], a[76:79], a[4:7], v[96:99]
    ds_read_b64_tr_b16 a[64:65], v32 offset:2112
    ds_read_b64_tr_b16 a[66:67], v32 offset:4416
    s_barrier
    s_add_u32 s58, s55, 1
    s_and_b32 s58, s58, 3
    s_lshl_b32 s58, s58, 14
    s_add_u32 s58, s58, s57
    buffer_load_dwordx4 a[16:19], v14, s[40:43], s58 offen offset:0 sc1
    buffer_load_dwordx4 a[20:23], v14, s[40:43], s58 offen offset:1024 sc1
    buffer_load_dwordx4 a[24:27], v14, s[40:43], s58 offen offset:2048 sc1
    buffer_load_dwordx4 a[28:31], v14, s[40:43], s58 offen offset:3072 sc1
    s_add_u32 s58, s55, 2
    s_and_b32 s58, s58, 3
    s_lshl_b32 s58, s58, 14
    s_add_u32 s58, s58, s57
    buffer_load_dwordx4 a[32:35], v14, s[40:43], s58 offen offset:0 sc1
    buffer_load_dwordx4 a[36:39], v14, s[40:43], s58 offen offset:1024 sc1
    buffer_load_dwordx4 a[40:43], v14, s[40:43], s58 offen offset:2048 sc1
    buffer_load_dwordx4 a[44:47], v14, s[40:43], s58 offen offset:3072 sc1
    s_add_u32 s58, s55, 3
    s_and_b32 s58, s58, 3
    s_lshl_b32 s58, s58, 14
    s_add_u32 s58, s58, s57
    buffer_load_dwordx4 a[48:51], v14, s[40:43], s58 offen offset:0 sc1
    buffer_load_dwordx4 a[52:55], v14, s[40:43], s58 offen offset:1024 sc1
    buffer_load_dwordx4 a[56:59], v14, s[40:43], s58 offen offset:2048 sc1
    buffer_load_dwordx4 a[60:63], v14, s[40:43], s58 offen offset:3072 sc1
    v_mfma_f32_16x16x32_bf16 v[100:103], a[80:83], a[4:7], v[100:103]
    ds_read_b64_tr_b16 a[68:69], v32 offset:2144
    ds_read_b64_tr_b16 a[70:71], v32 offset:4448
    v_mfma_f32_16x16x32_bf16 v[104:107], a[84:87], a[4:7], v[104:107]
    ds_read_b64_tr_b16 a[72:73], v32 offset:2176
    ds_read_b64_tr_b16 a[74:75], v32 offset:4480
    s_waitcnt lgkmcnt(6)
    v_mfma_f32_16x16x32_bf16 v[108:111], a[88:91], a[4:7], v[108:111]
    ds_read_b64_tr_b16 a[76:77], v32 offset:2208
    ds_read_b64_tr_b16 a[78:79], v32 offset:4512
    v_mfma_f32_16x16x32_bf16 v[112:115], a[92:95], a[4:7], v[112:115]
    ds_read_b64_tr_b16 a[80:81], v32 offset:2240
    ds_read_b64_tr_b16 a[82:83], v32 offset:4544
    s_waitcnt vmcnt(13)
    v_mfma_f32_16x16x32_bf16 v[80:83], a[96:99], a[8:11], v[80:83]
    ds_read_b64_tr_b16 a[84:85], v32 offset:2272
    ds_read_b64_tr_b16 a[86:87], v32 offset:4576
    v_mfma_f32_16x16x32_bf16 v[84:87], a[100:103], a[8:11], v[84:87]
    ds_read_b64_tr_b16 a[88:89], v32 offset:2304
    ds_read_b64_tr_b16 a[90:91], v32 offset:4608
    s_waitcnt lgkmcnt(6)
    v_mfma_f32_16x16x32_bf16 v[88:91], a[64:67], a[8:11], v[88:91]
    ds_read_b64_tr_b16 a[92:93], v32 offset:11264
    ds_read_b64_tr_b16 a[94:95], v32 offset:13568
    v_mfma_f32_16x16x32_bf16 v[92:95], a[68:71], a[8:11], v[92:95]
    ds_read_b64_tr_b16 a[96:97], v32 offset:11296
    ds_read_b64_tr_b16 a[98:99], v32 offset:13600
    v_mfma_f32_16x16x32_bf16 v[96:99], a[72:75], a[8:11], v[96:99]
    ds_read_b64_tr_b16 a[100:101], v32 offset:11328
    ds_read_b64_tr_b16 a[102:103], v32 offset:13632
    v_mfma_f32_16x16x32_bf16 v[100:103], a[76:79], a[8:11], v[100:103]
    ds_read_b64_tr_b16 a[64:65], v32 offset:11360
    ds_read_b64_tr_b16 a[66:67], v32 offset:13664
    s_waitcnt lgkmcnt(6)
    v_mfma_f32_16x16x32_bf16 v[104:107], a[80:83], a[8:11], v[104:107]
    ds_read_b64_tr_b16 a[68:69], v32 offset:11392
    ds_read_b64_tr_b16 a[70:71], v32 offset:13696
    v_mfma_f32_16x16x32_bf16 v[108:111], a[84:87], a[8:11], v[108:111]
    ds_read_b64_tr_b16 a[72:73], v32 offset:11424
    ds_read_b64_tr_b16 a[74:75], v32 offset:13728
    v_mfma_f32_16x16x32_bf16 v[112:115], a[88:91], a[8:11], v[112:115]
    ds_read_b64_tr_b16 a[76:77], v32 offset:11456
    ds_read_b64_tr_b16 a[78:79], v32 offset:13760
    s_waitcnt vmcnt(12)
    v_mfma_f32_16x16x32_bf16 v[80:83], a[92:95], a[12:15], v[80:83]
    ds_read_b64_tr_b16 a[80:81], v32 offset:11488
    ds_read_b64_tr_b16 a[82:83], v32 offset:13792
    s_waitcnt lgkmcnt(6)
    v_mfma_f32_16x16x32_bf16 v[84:87], a[96:99], a[12:15], v[84:87]
    ds_read_b64_tr_b16 a[84:85], v32 offset:11520
    ds_read_b64_tr_b16 a[86:87], v32 offset:13824
    v_mfma_f32_16x16x32_bf16 v[88:91], a[100:103], a[12:15], v[88:91]
    ds_read_b64_tr_b16 a[88:89], v32 offset:20480
    ds_read_b64_tr_b16 a[90:91], v32 offset:22784
    v_mfma_f32_16x16x32_bf16 v[92:95], a[64:67], a[12:15], v[92:95]
    ds_read_b64_tr_b16 a[92:93], v30 offset:0
    ds_read_b64_tr_b16 a[94:95], v30 offset:2304
    v_mfma_f32_16x16x32_bf16 v[96:99], a[68:71], a[12:15], v[96:99]
    ds_read_b64_tr_b16 a[96:97], v30 offset:9216
    ds_read_b64_tr_b16 a[98:99], v30 offset:11520
    s_waitcnt lgkmcnt(6)
    v_mfma_f32_16x16x32_bf16 v[100:103], a[72:75], a[12:15], v[100:103]
    ds_read_b64_tr_b16 a[100:101], v30 offset:18432
    ds_read_b64_tr_b16 a[102:103], v30 offset:20736
    v_mfma_f32_16x16x32_bf16 v[104:107], a[76:79], a[12:15], v[104:107]
    ds_read_b64_tr_b16 a[64:65], v30 offset:27648
    ds_read_b64_tr_b16 a[66:67], v30 offset:29952
    v_mfma_f32_16x16x32_bf16 v[108:111], a[80:83], a[12:15], v[108:111]
    ds_read_b64_tr_b16 a[68:69], v30 offset:36864
    ds_read_b64_tr_b16 a[70:71], v30 offset:39168
    v_mfma_f32_16x16x32_bf16 v[112:115], a[84:87], a[12:15], v[112:115]
    ds_read_b64_tr_b16 a[72:73], v30 offset:46080
    ds_read_b64_tr_b16 a[74:75], v30 offset:48384
    s_waitcnt vmcnt(11)
    s_waitcnt lgkmcnt(6)
    v_mfma_f32_16x16x32_bf16 v[80:83], a[88:91], a[16:19], v[80:83]
    ds_read_b64_tr_b16 a[76:77], v30 offset:55296
    ds_read_b64_tr_b16 a[78:79], v30 offset:57600
    s_waitcnt vmcnt(10)
    v_mfma_f32_16x16x32_bf16 v[80:83], a[92:95], a[20:23], v[80:83]
    ds_read_b64_tr_b16 a[80:81], v30 offset:64512
    ds_read_b64_tr_b16 a[82:83], v31 offset:1280
    s_waitcnt vmcnt(9)
    v_mfma_f32_16x16x32_bf16 v[80:83], a[96:99], a[24:27], v[80:83]
    ds_read_b64_tr_b16 a[84:85], v31 offset:8192
    ds_read_b64_tr_b16 a[86:87], v31 offset:10496
    s_waitcnt vmcnt(8)
    v_mfma_f32_16x16x32_bf16 v[80:83], a[100:103], a[28:31], v[80:83]
    ds_read_b64_tr_b16 a[88:89], v31 offset:17408
    ds_read_b64_tr_b16 a[90:91], v31 offset:19712
    s_waitcnt vmcnt(7)
    s_waitcnt lgkmcnt(6)
    v_mfma_f32_16x16x32_bf16 v[80:83], a[64:67], a[32:35], v[80:83]
    ds_read_b64_tr_b16 a[92:93], v31 offset:26624
    ds_read_b64_tr_b16 a[94:95], v31 offset:28928
    s_waitcnt vmcnt(6)
    v_mfma_f32_16x16x32_bf16 v[80:83], a[68:71], a[36:39], v[80:83]
    ds_read_b64_tr_b16 a[96:97], v32 offset:20512
    ds_read_b64_tr_b16 a[98:99], v32 offset:22816
    s_waitcnt vmcnt(5)
    v_mfma_f32_16x16x32_bf16 v[80:83], a[72:75], a[40:43], v[80:83]
    ds_read_b64_tr_b16 a[100:101], v30 offset:32
    ds_read_b64_tr_b16 a[102:103], v30 offset:2336
    s_waitcnt vmcnt(4)
    v_mfma_f32_16x16x32_bf16 v[80:83], a[76:79], a[44:47], v[80:83]
    ds_read_b64_tr_b16 a[64:65], v30 offset:9248
    ds_read_b64_tr_b16 a[66:67], v30 offset:11552
    s_waitcnt vmcnt(3)
    s_waitcnt lgkmcnt(6)
    v_mfma_f32_16x16x32_bf16 v[80:83], a[80:83], a[48:51], v[80:83]
    ds_read_b64_tr_b16 a[68:69], v30 offset:18464
    ds_read_b64_tr_b16 a[70:71], v30 offset:20768
    s_waitcnt vmcnt(2)
    v_mfma_f32_16x16x32_bf16 v[80:83], a[84:87], a[52:55], v[80:83]
    ds_read_b64_tr_b16 a[72:73], v30 offset:27680
    ds_read_b64_tr_b16 a[74:75], v30 offset:29984
    s_waitcnt vmcnt(1)
    v_mfma_f32_16x16x32_bf16 v[80:83], a[88:91], a[56:59], v[80:83]
    ds_read_b64_tr_b16 a[76:77], v30 offset:36896
    ds_read_b64_tr_b16 a[78:79], v30 offset:39200
    s_waitcnt vmcnt(0)
    v_mfma_f32_16x16x32_bf16 v[80:83], a[92:95], a[60:63], v[80:83]
    ds_read_b64_tr_b16 a[80:81], v30 offset:46112
    ds_read_b64_tr_b16 a[82:83], v30 offset:48416
    s_waitcnt lgkmcnt(6)
    v_mfma_f32_16x16x32_bf16 v[84:87], a[96:99], a[16:19], v[84:87]
    ds_read_b64_tr_b16 a[84:85], v30 offset:55328
    ds_read_b64_tr_b16 a[86:87], v30 offset:57632
    v_mfma_f32_16x16x32_bf16 v[84:87], a[100:103], a[20:23], v[84:87]
    ds_read_b64_tr_b16 a[88:89], v30 offset:64544
    ds_read_b64_tr_b16 a[90:91], v31 offset:1312
    v_mfma_f32_16x16x32_bf16 v[84:87], a[64:67], a[24:27], v[84:87]
    ds_read_b64_tr_b16 a[92:93], v31 offset:8224
    ds_read_b64_tr_b16 a[94:95], v31 offset:10528
    v_mfma_f32_16x16x32_bf16 v[84:87], a[68:71], a[28:31], v[84:87]
    ds_read_b64_tr_b16 a[96:97], v31 offset:17440
    ds_read_b64_tr_b16 a[98:99], v31 offset:19744
    s_waitcnt lgkmcnt(6)
    v_mfma_f32_16x16x32_bf16 v[84:87], a[72:75], a[32:35], v[84:87]
    ds_read_b64_tr_b16 a[100:101], v31 offset:26656
    ds_read_b64_tr_b16 a[102:103], v31 offset:28960
    v_mfma_f32_16x16x32_bf16 v[84:87], a[76:79], a[36:39], v[84:87]
    ds_read_b64_tr_b16 a[64:65], v32 offset:20544
    ds_read_b64_tr_b16 a[66:67], v32 offset:22848
    v_mfma_f32_16x16x32_bf16 v[84:87], a[80:83], a[40:43], v[84:87]
    ds_read_b64_tr_b16 a[68:69], v30 offset:64
    ds_read_b64_tr_b16 a[70:71], v30 offset:2368
    v_mfma_f32_16x16x32_bf16 v[84:87], a[84:87], a[44:47], v[84:87]
    ds_read_b64_tr_b16 a[72:73], v30 offset:9280
    ds_read_b64_tr_b16 a[74:75], v30 offset:11584
    s_waitcnt lgkmcnt(6)
    v_mfma_f32_16x16x32_bf16 v[84:87], a[88:91], a[48:51], v[84:87]
    ds_read_b64_tr_b16 a[76:77], v30 offset:18496
    ds_read_b64_tr_b16 a[78:79], v30 offset:20800
    v_cvt_pk_bf16_f32 v116, v80, v81
    v_cvt_pk_bf16_f32 v117, v82, v83
    v_mfma_f32_16x16x32_bf16 v[84:87], a[92:95], a[52:55], v[84:87]
    ds_read_b64_tr_b16 a[80:81], v30 offset:27712
    ds_read_b64_tr_b16 a[82:83], v30 offset:30016
    v_mfma_f32_16x16x32_bf16 v[84:87], a[96:99], a[56:59], v[84:87]
    ds_read_b64_tr_b16 a[84:85], v30 offset:36928
    ds_read_b64_tr_b16 a[86:87], v30 offset:39232
    v_mfma_f32_16x16x32_bf16 v[84:87], a[100:103], a[60:63], v[84:87]
    ds_read_b64_tr_b16 a[88:89], v30 offset:46144
    ds_read_b64_tr_b16 a[90:91], v30 offset:48448
    s_waitcnt lgkmcnt(6)
    v_mfma_f32_16x16x32_bf16 v[88:91], a[64:67], a[16:19], v[88:91]
    ds_read_b64_tr_b16 a[92:93], v30 offset:55360
    ds_read_b64_tr_b16 a[94:95], v30 offset:57664
    v_mfma_f32_16x16x32_bf16 v[88:91], a[68:71], a[20:23], v[88:91]
    ds_read_b64_tr_b16 a[96:97], v30 offset:64576
    ds_read_b64_tr_b16 a[98:99], v31 offset:1344
    v_mfma_f32_16x16x32_bf16 v[88:91], a[72:75], a[24:27], v[88:91]
    ds_read_b64_tr_b16 a[100:101], v31 offset:8256
    ds_read_b64_tr_b16 a[102:103], v31 offset:10560
    v_mfma_f32_16x16x32_bf16 v[88:91], a[76:79], a[28:31], v[88:91]
    ds_read_b64_tr_b16 a[64:65], v31 offset:17472
    ds_read_b64_tr_b16 a[66:67], v31 offset:19776
    s_waitcnt lgkmcnt(6)
    v_mfma_f32_16x16x32_bf16 v[88:91], a[80:83], a[32:35], v[88:91]
    ds_read_b64_tr_b16 a[68:69], v31 offset:26688
    ds_read_b64_tr_b16 a[70:71], v31 offset:28992
    v_mfma_f32_16x16x32_bf16 v[88:91], a[84:87], a[36:39], v[88:91]
    ds_read_b64_tr_b16 a[72:73], v32 offset:20576
    ds_read_b64_tr_b16 a[74:75], v32 offset:22880
    v_mfma_f32_16x16x32_bf16 v[88:91], a[88:91], a[40:43], v[88:91]
    ds_read_b64_tr_b16 a[76:77], v30 offset:96
    ds_read_b64_tr_b16 a[78:79], v30 offset:2400
    v_mfma_f32_16x16x32_bf16 v[88:91], a[92:95], a[44:47], v[88:91]
    ds_read_b64_tr_b16 a[80:81], v30 offset:9312
    ds_read_b64_tr_b16 a[82:83], v30 offset:11616
    s_waitcnt lgkmcnt(6)
    v_mfma_f32_16x16x32_bf16 v[88:91], a[96:99], a[48:51], v[88:91]
    ds_read_b64_tr_b16 a[84:85], v30 offset:18528
    ds_read_b64_tr_b16 a[86:87], v30 offset:20832
    v_cvt_pk_bf16_f32 v118, v84, v85
    v_cvt_pk_bf16_f32 v119, v86, v87
    buffer_store_dwordx4 v[116:119], v14, s[40:43], s59 offen offset:0 sc1
    v_mfma_f32_16x16x32_bf16 v[88:91], a[100:103], a[52:55], v[88:91]
    ds_read_b64_tr_b16 a[88:89], v30 offset:27744
    ds_read_b64_tr_b16 a[90:91], v30 offset:30048
    v_mfma_f32_16x16x32_bf16 v[88:91], a[64:67], a[56:59], v[88:91]
    ds_read_b64_tr_b16 a[92:93], v30 offset:36960
    ds_read_b64_tr_b16 a[94:95], v30 offset:39264
    v_mfma_f32_16x16x32_bf16 v[88:91], a[68:71], a[60:63], v[88:91]
    ds_read_b64_tr_b16 a[96:97], v30 offset:46176
    ds_read_b64_tr_b16 a[98:99], v30 offset:48480
    s_waitcnt lgkmcnt(6)
    v_mfma_f32_16x16x32_bf16 v[92:95], a[72:75], a[16:19], v[92:95]
    ds_read_b64_tr_b16 a[100:101], v30 offset:55392
    ds_read_b64_tr_b16 a[102:103], v30 offset:57696
    v_mfma_f32_16x16x32_bf16 v[92:95], a[76:79], a[20:23], v[92:95]
    ds_read_b64_tr_b16 a[64:65], v30 offset:64608
    ds_read_b64_tr_b16 a[66:67], v31 offset:1376
    v_mfma_f32_16x16x32_bf16 v[92:95], a[80:83], a[24:27], v[92:95]
    ds_read_b64_tr_b16 a[68:69], v31 offset:8288
    ds_read_b64_tr_b16 a[70:71], v31 offset:10592
    v_mfma_f32_16x16x32_bf16 v[92:95], a[84:87], a[28:31], v[92:95]
    ds_read_b64_tr_b16 a[72:73], v31 offset:17504
    ds_read_b64_tr_b16 a[74:75], v31 offset:19808
    s_waitcnt lgkmcnt(6)
    v_mfma_f32_16x16x32_bf16 v[92:95], a[88:91], a[32:35], v[92:95]
    ds_read_b64_tr_b16 a[76:77], v31 offset:26720
    ds_read_b64_tr_b16 a[78:79], v31 offset:29024
    v_mfma_f32_16x16x32_bf16 v[92:95], a[92:95], a[36:39], v[92:95]
    ds_read_b64_tr_b16 a[80:81], v32 offset:20608
    ds_read_b64_tr_b16 a[82:83], v32 offset:22912
    v_mfma_f32_16x16x32_bf16 v[92:95], a[96:99], a[40:43], v[92:95]
    ds_read_b64_tr_b16 a[84:85], v30 offset:128
    ds_read_b64_tr_b16 a[86:87], v30 offset:2432
    v_mfma_f32_16x16x32_bf16 v[92:95], a[100:103], a[44:47], v[92:95]
    ds_read_b64_tr_b16 a[88:89], v30 offset:9344
    ds_read_b64_tr_b16 a[90:91], v30 offset:11648
    s_waitcnt lgkmcnt(6)
    v_mfma_f32_16x16x32_bf16 v[92:95], a[64:67], a[48:51], v[92:95]
    ds_read_b64_tr_b16 a[92:93], v30 offset:18560
    ds_read_b64_tr_b16 a[94:95], v30 offset:20864
    v_cvt_pk_bf16_f32 v120, v88, v89
    v_cvt_pk_bf16_f32 v121, v90, v91
    v_mfma_f32_16x16x32_bf16 v[92:95], a[68:71], a[52:55], v[92:95]
    ds_read_b64_tr_b16 a[96:97], v30 offset:27776
    ds_read_b64_tr_b16 a[98:99], v30 offset:30080
    v_mfma_f32_16x16x32_bf16 v[92:95], a[72:75], a[56:59], v[92:95]
    ds_read_b64_tr_b16 a[100:101], v30 offset:36992
    ds_read_b64_tr_b16 a[102:103], v30 offset:39296
    v_mfma_f32_16x16x32_bf16 v[92:95], a[76:79], a[60:63], v[92:95]
    ds_read_b64_tr_b16 a[64:65], v30 offset:46208
    ds_read_b64_tr_b16 a[66:67], v30 offset:48512
    s_waitcnt lgkmcnt(6)
    v_mfma_f32_16x16x32_bf16 v[96:99], a[80:83], a[16:19], v[96:99]
    ds_read_b64_tr_b16 a[68:69], v30 offset:55424
    ds_read_b64_tr_b16 a[70:71], v30 offset:57728
    v_mfma_f32_16x16x32_bf16 v[96:99], a[84:87], a[20:23], v[96:99]
    ds_read_b64_tr_b16 a[72:73], v30 offset:64640
    ds_read_b64_tr_b16 a[74:75], v31 offset:1408
    v_mfma_f32_16x16x32_bf16 v[96:99], a[88:91], a[24:27], v[96:99]
    ds_read_b64_tr_b16 a[76:77], v31 offset:8320
    ds_read_b64_tr_b16 a[78:79], v31 offset:10624
    v_mfma_f32_16x16x32_bf16 v[96:99], a[92:95], a[28:31], v[96:99]
    ds_read_b64_tr_b16 a[80:81], v31 offset:17536
    ds_read_b64_tr_b16 a[82:83], v31 offset:19840
    s_waitcnt lgkmcnt(6)
    v_mfma_f32_16x16x32_bf16 v[96:99], a[96:99], a[32:35], v[96:99]
    ds_read_b64_tr_b16 a[84:85], v31 offset:26752
    ds_read_b64_tr_b16 a[86:87], v31 offset:29056
    v_mfma_f32_16x16x32_bf16 v[96:99], a[100:103], a[36:39], v[96:99]
    ds_read_b64_tr_b16 a[88:89], v32 offset:20640
    ds_read_b64_tr_b16 a[90:91], v32 offset:22944
    v_mfma_f32_16x16x32_bf16 v[96:99], a[64:67], a[40:43], v[96:99]
    ds_read_b64_tr_b16 a[92:93], v30 offset:160
    ds_read_b64_tr_b16 a[94:95], v30 offset:2464
    v_mfma_f32_16x16x32_bf16 v[96:99], a[68:71], a[44:47], v[96:99]
    ds_read_b64_tr_b16 a[96:97], v30 offset:9376
    ds_read_b64_tr_b16 a[98:99], v30 offset:11680
    s_waitcnt lgkmcnt(6)
    v_mfma_f32_16x16x32_bf16 v[96:99], a[72:75], a[48:51], v[96:99]
    ds_read_b64_tr_b16 a[100:101], v30 offset:18592
    ds_read_b64_tr_b16 a[102:103], v30 offset:20896
    v_cvt_pk_bf16_f32 v122, v92, v93
    v_cvt_pk_bf16_f32 v123, v94, v95
    buffer_store_dwordx4 v[120:123], v14, s[40:43], s59 offen offset:1024 sc1
    v_mfma_f32_16x16x32_bf16 v[96:99], a[76:79], a[52:55], v[96:99]
    ds_read_b64_tr_b16 a[64:65], v30 offset:27808
    ds_read_b64_tr_b16 a[66:67], v30 offset:30112
    v_mfma_f32_16x16x32_bf16 v[96:99], a[80:83], a[56:59], v[96:99]
    ds_read_b64_tr_b16 a[68:69], v30 offset:37024
    ds_read_b64_tr_b16 a[70:71], v30 offset:39328
    v_mfma_f32_16x16x32_bf16 v[96:99], a[84:87], a[60:63], v[96:99]
    ds_read_b64_tr_b16 a[72:73], v30 offset:46240
    ds_read_b64_tr_b16 a[74:75], v30 offset:48544
    s_waitcnt lgkmcnt(6)
    v_mfma_f32_16x16x32_bf16 v[100:103], a[88:91], a[16:19], v[100:103]
    ds_read_b64_tr_b16 a[76:77], v30 offset:55456
    ds_read_b64_tr_b16 a[78:79], v30 offset:57760
    v_mfma_f32_16x16x32_bf16 v[100:103], a[92:95], a[20:23], v[100:103]
    ds_read_b64_tr_b16 a[80:81], v30 offset:64672
    ds_read_b64_tr_b16 a[82:83], v31 offset:1440
    v_mfma_f32_16x16x32_bf16 v[100:103], a[96:99], a[24:27], v[100:103]
    ds_read_b64_tr_b16 a[84:85], v31 offset:8352
    ds_read_b64_tr_b16 a[86:87], v31 offset:10656
    v_mfma_f32_16x16x32_bf16 v[100:103], a[100:103], a[28:31], v[100:103]
    ds_read_b64_tr_b16 a[88:89], v31 offset:17568
    ds_read_b64_tr_b16 a[90:91], v31 offset:19872
    s_waitcnt lgkmcnt(6)
    v_mfma_f32_16x16x32_bf16 v[100:103], a[64:67], a[32:35], v[100:103]
    ds_read_b64_tr_b16 a[92:93], v31 offset:26784
    ds_read_b64_tr_b16 a[94:95], v31 offset:29088
    v_mfma_f32_16x16x32_bf16 v[100:103], a[68:71], a[36:39], v[100:103]
    ds_read_b64_tr_b16 a[96:97], v32 offset:20672
    ds_read_b64_tr_b16 a[98:99], v32 offset:22976
    v_mfma_f32_16x16x32_bf16 v[100:103], a[72:75], a[40:43], v[100:103]
    ds_read_b64_tr_b16 a[100:101], v30 offset:192
    ds_read_b64_tr_b16 a[102:103], v30 offset:2496
    v_mfma_f32_16x16x32_bf16 v[100:103], a[76:79], a[44:47], v[100:103]
    ds_read_b64_tr_b16 a[64:65], v30 offset:9408
    ds_read_b64_tr_b16 a[66:67], v30 offset:11712
    s_waitcnt lgkmcnt(6)
    v_mfma_f32_16x16x32_bf16 v[100:103], a[80:83], a[48:51], v[100:103]
    ds_read_b64_tr_b16 a[68:69], v30 offset:18624
    ds_read_b64_tr_b16 a[70:71], v30 offset:20928
    v_cvt_pk_bf16_f32 v124, v96, v97
    v_cvt_pk_bf16_f32 v125, v98, v99
    v_mfma_f32_16x16x32_bf16 v[100:103], a[84:87], a[52:55], v[100:103]
    ds_read_b64_tr_b16 a[72:73], v30 offset:27840
    ds_read_b64_tr_b16 a[74:75], v30 offset:30144
    v_mfma_f32_16x16x32_bf16 v[100:103], a[88:91], a[56:59], v[100:103]
    ds_read_b64_tr_b16 a[76:77], v30 offset:37056
    ds_read_b64_tr_b16 a[78:79], v30 offset:39360
    v_mfma_f32_16x16x32_bf16 v[100:103], a[92:95], a[60:63], v[100:103]
    ds_read_b64_tr_b16 a[80:81], v30 offset:46272
    ds_read_b64_tr_b16 a[82:83], v30 offset:48576
    s_waitcnt lgkmcnt(6)
    v_mfma_f32_16x16x32_bf16 v[104:107], a[96:99], a[16:19], v[104:107]
    ds_read_b64_tr_b16 a[84:85], v30 offset:55488
    ds_read_b64_tr_b16 a[86:87], v30 offset:57792
    v_mfma_f32_16x16x32_bf16 v[104:107], a[100:103], a[20:23], v[104:107]
    ds_read_b64_tr_b16 a[88:89], v30 offset:64704
    ds_read_b64_tr_b16 a[90:91], v31 offset:1472
    v_mfma_f32_16x16x32_bf16 v[104:107], a[64:67], a[24:27], v[104:107]
    ds_read_b64_tr_b16 a[92:93], v31 offset:8384
    ds_read_b64_tr_b16 a[94:95], v31 offset:10688
    v_mfma_f32_16x16x32_bf16 v[104:107], a[68:71], a[28:31], v[104:107]
    ds_read_b64_tr_b16 a[96:97], v31 offset:17600
    ds_read_b64_tr_b16 a[98:99], v31 offset:19904
    s_waitcnt lgkmcnt(6)
    v_mfma_f32_16x16x32_bf16 v[104:107], a[72:75], a[32:35], v[104:107]
    ds_read_b64_tr_b16 a[100:101], v31 offset:26816
    ds_read_b64_tr_b16 a[102:103], v31 offset:29120
    v_mfma_f32_16x16x32_bf16 v[104:107], a[76:79], a[36:39], v[104:107]
    ds_read_b64_tr_b16 a[64:65], v32 offset:20704
    ds_read_b64_tr_b16 a[66:67], v32 offset:23008
    v_mfma_f32_16x16x32_bf16 v[104:107], a[80:83], a[40:43], v[104:107]
    ds_read_b64_tr_b16 a[68:69], v30 offset:224
    ds_read_b64_tr_b16 a[70:71], v30 offset:2528
    v_mfma_f32_16x16x32_bf16 v[104:107], a[84:87], a[44:47], v[104:107]
    ds_read_b64_tr_b16 a[72:73], v30 offset:9440
    ds_read_b64_tr_b16 a[74:75], v30 offset:11744
    s_waitcnt lgkmcnt(6)
    v_mfma_f32_16x16x32_bf16 v[104:107], a[88:91], a[48:51], v[104:107]
    ds_read_b64_tr_b16 a[76:77], v30 offset:18656
    ds_read_b64_tr_b16 a[78:79], v30 offset:20960
    v_cvt_pk_bf16_f32 v126, v100, v101
    v_cvt_pk_bf16_f32 v127, v102, v103
    buffer_store_dwordx4 v[124:127], v14, s[40:43], s59 offen offset:2048 sc1
    v_mfma_f32_16x16x32_bf16 v[104:107], a[92:95], a[52:55], v[104:107]
    ds_read_b64_tr_b16 a[80:81], v30 offset:27872
    ds_read_b64_tr_b16 a[82:83], v30 offset:30176
    v_mfma_f32_16x16x32_bf16 v[104:107], a[96:99], a[56:59], v[104:107]
    ds_read_b64_tr_b16 a[84:85], v30 offset:37088
    ds_read_b64_tr_b16 a[86:87], v30 offset:39392
    v_mfma_f32_16x16x32_bf16 v[104:107], a[100:103], a[60:63], v[104:107]
    ds_read_b64_tr_b16 a[88:89], v30 offset:46304
    ds_read_b64_tr_b16 a[90:91], v30 offset:48608
    s_waitcnt lgkmcnt(6)
    v_mfma_f32_16x16x32_bf16 v[108:111], a[64:67], a[16:19], v[108:111]
    ds_read_b64_tr_b16 a[92:93], v30 offset:55520
    ds_read_b64_tr_b16 a[94:95], v30 offset:57824
    v_mfma_f32_16x16x32_bf16 v[108:111], a[68:71], a[20:23], v[108:111]
    ds_read_b64_tr_b16 a[96:97], v30 offset:64736
    ds_read_b64_tr_b16 a[98:99], v31 offset:1504
    v_mfma_f32_16x16x32_bf16 v[108:111], a[72:75], a[24:27], v[108:111]
    ds_read_b64_tr_b16 a[100:101], v31 offset:8416
    ds_read_b64_tr_b16 a[102:103], v31 offset:10720
    v_mfma_f32_16x16x32_bf16 v[108:111], a[76:79], a[28:31], v[108:111]
    ds_read_b64_tr_b16 a[64:65], v31 offset:17632
    ds_read_b64_tr_b16 a[66:67], v31 offset:19936
    s_waitcnt lgkmcnt(6)
    v_mfma_f32_16x16x32_bf16 v[108:111], a[80:83], a[32:35], v[108:111]
    ds_read_b64_tr_b16 a[68:69], v31 offset:26848
    ds_read_b64_tr_b16 a[70:71], v31 offset:29152
    v_mfma_f32_16x16x32_bf16 v[108:111], a[84:87], a[36:39], v[108:111]
    ds_read_b64_tr_b16 a[72:73], v32 offset:20736
    ds_read_b64_tr_b16 a[74:75], v32 offset:23040
    v_mfma_f32_16x16x32_bf16 v[108:111], a[88:91], a[40:43], v[108:111]
    ds_read_b64_tr_b16 a[76:77], v30 offset:256
    ds_read_b64_tr_b16 a[78:79], v30 offset:2560
    v_mfma_f32_16x16x32_bf16 v[108:111], a[92:95], a[44:47], v[108:111]
    ds_read_b64_tr_b16 a[80:81], v30 offset:9472
    ds_read_b64_tr_b16 a[82:83], v30 offset:11776
    s_waitcnt lgkmcnt(6)
    v_mfma_f32_16x16x32_bf16 v[108:111], a[96:99], a[48:51], v[108:111]
    ds_read_b64_tr_b16 a[84:85], v30 offset:18688
    ds_read_b64_tr_b16 a[86:87], v30 offset:20992
    v_cvt_pk_bf16_f32 v128, v104, v105
    v_cvt_pk_bf16_f32 v129, v106, v107
    v_mfma_f32_16x16x32_bf16 v[108:111], a[100:103], a[52:55], v[108:111]
    ds_read_b64_tr_b16 a[88:89], v30 offset:27904
    ds_read_b64_tr_b16 a[90:91], v30 offset:30208
    v_mfma_f32_16x16x32_bf16 v[108:111], a[64:67], a[56:59], v[108:111]
    ds_read_b64_tr_b16 a[92:93], v30 offset:37120
    ds_read_b64_tr_b16 a[94:95], v30 offset:39424
    v_mfma_f32_16x16x32_bf16 v[108:111], a[68:71], a[60:63], v[108:111]
    ds_read_b64_tr_b16 a[96:97], v30 offset:46336
    ds_read_b64_tr_b16 a[98:99], v30 offset:48640
    s_waitcnt lgkmcnt(6)
    v_mfma_f32_16x16x32_bf16 v[112:115], a[72:75], a[16:19], v[112:115]
    ds_read_b64_tr_b16 a[100:101], v30 offset:55552
    ds_read_b64_tr_b16 a[102:103], v30 offset:57856
    v_mfma_f32_16x16x32_bf16 v[112:115], a[76:79], a[20:23], v[112:115]
    ds_read_b64_tr_b16 a[64:65], v30 offset:64768
    ds_read_b64_tr_b16 a[66:67], v31 offset:1536
    v_mfma_f32_16x16x32_bf16 v[112:115], a[80:83], a[24:27], v[112:115]
    ds_read_b64_tr_b16 a[68:69], v31 offset:8448
    ds_read_b64_tr_b16 a[70:71], v31 offset:10752
    v_mfma_f32_16x16x32_bf16 v[112:115], a[84:87], a[28:31], v[112:115]
    ds_read_b64_tr_b16 a[72:73], v31 offset:17664
    ds_read_b64_tr_b16 a[74:75], v31 offset:19968
    s_waitcnt lgkmcnt(6)
    v_mfma_f32_16x16x32_bf16 v[112:115], a[88:91], a[32:35], v[112:115]
    ds_read_b64_tr_b16 a[76:77], v31 offset:26880
    ds_read_b64_tr_b16 a[78:79], v31 offset:29184
    v_mfma_f32_16x16x32_bf16 v[112:115], a[92:95], a[36:39], v[112:115]
    v_mfma_f32_16x16x32_bf16 v[112:115], a[96:99], a[40:43], v[112:115]
    v_mfma_f32_16x16x32_bf16 v[112:115], a[100:103], a[44:47], v[112:115]
    s_waitcnt lgkmcnt(0)
    v_mfma_f32_16x16x32_bf16 v[112:115], a[64:67], a[48:51], v[112:115]
    v_cvt_pk_bf16_f32 v130, v108, v109
    v_cvt_pk_bf16_f32 v131, v110, v111
    buffer_store_dwordx4 v[128:131], v14, s[40:43], s59 offen offset:3072 sc1
    v_mfma_f32_16x16x32_bf16 v[112:115], a[68:71], a[52:55], v[112:115]
    v_mfma_f32_16x16x32_bf16 v[112:115], a[72:75], a[56:59], v[112:115]
    v_mfma_f32_16x16x32_bf16 v[112:115], a[76:79], a[60:63], v[112:115]
    s_nop 7
    v_cvt_pk_bf16_f32 v132, v112, v113
    v_cvt_pk_bf16_f32 v133, v114, v115
    s_add_u32 s59, s59, 4096
    buffer_store_dwordx4 v[132:135], v14, s[40:43], s59 offen sc1
    s_mul_i32 s57, s54, 160
    v_add_u32 v18, s57, v0
    v_lshlrev_b32 v19, 4, v18
    v_mul_u32_u24 v20, 3277, v18
    v_lshrrev_b32 v20, 20, v20
    v_mul_u32_u24 v21, 320, v20
    v_sub_u32 v21, v18, v21
    v_lshrrev_b32 v22, 6, v21
    v_and_b32 v23, 63, v18
    v_and_b32 v24, 15, v23
    v_lshl_add_u32 v24, v20, 4, v24
    v_mul_u32_u24 v24, 1152, v24
    v_lshrrev_b32 v25, 4, v23
    v_lshlrev_b32 v25, 3, v25
    v_lshl_add_u32 v25, v22, 6, v25
    v_add_u32 v24, v24, v25
    s_lshl_b32 s57, s53, 2
    s_add_u32 s57, s57, s55
    s_mul_i32 s57, s57, 163840
    s_add_u32 s57, s57, 8388608
    s_waitcnt vmcnt(0)
    s_barrier
    s_barrier
    v_cmp_gt_u32 vcc, 160, v0
    s_and_saveexec_b64 s[72:73], vcc
    s_cbranch_execz L_end
    s_mov_b32 s58, s57
    buffer_load_dwordx4 v[48:51], v19, s[40:43], s58 offen sc1
    s_add_u32 s58, s58, 20480
    buffer_load_dwordx4 v[52:55], v19, s[40:43], s58 offen sc1
    s_add_u32 s58, s58, 20480
    buffer_load_dwordx4 v[56:59], v19, s[40:43], s58 offen sc1
    s_add_u32 s58, s58, 20480
    buffer_load_dwordx4 v[60:63], v19, s[40:43], s58 offen sc1
    s_add_u32 s58, s58, 20480
    buffer_load_dwordx4 v[64:67], v19, s[40:43], s58 offen sc1
    s_add_u32 s58, s58, 20480
    buffer_load_dwordx4 v[68:71], v19, s[40:43], s58 offen sc1
    s_add_u32 s58, s58, 20480
    buffer_load_dwordx4 v[72:75], v19, s[40:43], s58 offen sc1
    s_add_u32 s58, s58, 20480
    buffer_load_dwordx4 v[76:79], v19, s[40:43], s58 offen sc1
L_have_c39:
    s_mul_i32 s57, s53, 73728
    s_mul_i32 s58, s55, 288
    s_add_u32 s57, s57, s58
    s_mov_b32 s58, 0xffff0000
    s_waitcnt vmcnt(7)
    v_lshlrev_b32 v80, 16, v48
    v_and_b32 v81, s58, v48
    v_lshlrev_b32 v82, 16, v49
    v_and_b32 v83, s58, v49
    v_lshlrev_b32 v84, 16, v50
    v_and_b32 v85, s58, v50
    v_lshlrev_b32 v86, 16, v51
    v_and_b32 v87, s58, v51
    s_waitcnt vmcnt(6)
    v_lshlrev_b32 v26, 16, v52
    v_and_b32 v27, s58, v52
    v_pk_add_f32 v[80:81], v[80:81], v[26:27]
    v_lshlrev_b32 v28, 16, v53
    v_and_b32 v29, s58, v53
    v_pk_add_f32 v[82:83], v[82:83], v[28:29]
    v_lshlrev_b32 v26, 16, v54
    v_and_b32 v27, s58, v54
    v_pk_add_f32 v[84:85], v[84:85], v[26:27]
    v_lshlrev_b32 v28, 16, v55
    v_and_b32 v29, s58, v55
    v_pk_add_f32 v[86:87], v[86:87], v[28:29]
    s_waitcnt vmcnt(5)
    v_lshlrev_b32 v26, 16, v56
    v_and_b32 v27, s58, v56
    v_pk_add_f32 v[80:81], v[80:81], v[26:27]
    v_lshlrev_b32 v28, 16, v57
    v_and_b32 v29, s58, v57
    v_pk_add_f32 v[82:83], v[82:83], v[28:29]
    v_lshlrev_b32 v26, 16, v58
    v_and_b32 v27, s58, v58
    v_pk_add_f32 v[84:85], v[84:85], v[26:27]
    v_lshlrev_b32 v28, 16, v59
    v_and_b32 v29, s58, v59
    v_pk_add_f32 v[86:87], v[86:87], v[28:29]
    s_waitcnt vmcnt(4)
    v_lshlrev_b32 v26, 16, v60
    v_and_b32 v27, s58, v60
    v_pk_add_f32 v[80:81], v[80:81], v[26:27]
    v_lshlrev_b32 v28, 16, v61
    v_and_b32 v29, s58, v61
    v_pk_add_f32 v[82:83], v[82:83], v[28:29]
    v_lshlrev_b32 v26, 16, v62
    v_and_b32 v27, s58, v62
    v_pk_add_f32 v[84:85], v[84:85], v[26:27]
    v_lshlrev_b32 v28, 16, v63
    v_and_b32 v29, s58, v63
    v_pk_add_f32 v[86:87], v[86:87], v[28:29]
    s_waitcnt vmcnt(3)
    v_lshlrev_b32 v26, 16, v64
    v_and_b32 v27, s58, v64
    v_pk_add_f32 v[80:81], v[80:81], v[26:27]
    v_lshlrev_b32 v28, 16, v65
    v_and_b32 v29, s58, v65
    v_pk_add_f32 v[82:83], v[82:83], v[28:29]
    v_lshlrev_b32 v26, 16, v66
    v_and_b32 v27, s58, v66
    v_pk_add_f32 v[84:85], v[84:85], v[26:27]
    v_lshlrev_b32 v28, 16, v67
    v_and_b32 v29, s58, v67
    v_pk_add_f32 v[86:87], v[86:87], v[28:29]
    s_waitcnt vmcnt(2)
    v_lshlrev_b32 v26, 16, v68
    v_and_b32 v27, s58, v68
    v_pk_add_f32 v[80:81], v[80:81], v[26:27]
    v_lshlrev_b32 v28, 16, v69
    v_and_b32 v29, s58, v69
    v_pk_add_f32 v[82:83], v[82:83], v[28:29]
    v_lshlrev_b32 v26, 16, v70
    v_and_b32 v27, s58, v70
    v_pk_add_f32 v[84:85], v[84:85], v[26:27]
    v_lshlrev_b32 v28, 16, v71
    v_and_b32 v29, s58, v71
    v_pk_add_f32 v[86:87], v[86:87], v[28:29]
    s_waitcnt vmcnt(1)
    v_lshlrev_b32 v26, 16, v72
    v_and_b32 v27, s58, v72
    v_pk_add_f32 v[80:81], v[80:81], v[26:27]
    v_lshlrev_b32 v28, 16, v73
    v_and_b32 v29, s58, v73
    v_pk_add_f32 v[82:83], v[82:83], v[28:29]
    v_lshlrev_b32 v26, 16, v74
    v_and_b32 v27, s58, v74
    v_pk_add_f32 v[84:85], v[84:85], v[26:27]
    v_lshlrev_b32 v28, 16, v75
    v_and_b32 v29, s58, v75
    v_pk_add_f32 v[86:87], v[86:87], v[28:29]
    s_waitcnt vmcnt(0)
    v_lshlrev_b32 v26, 16, v76
    v_and_b32 v27, s58, v76
    v_pk_add_f32 v[80:81], v[80:81], v[26:27]
    v_lshlrev_b32 v28, 16, v77
    v_and_b32 v29, s58, v77
    v_pk_add_f32 v[82:83], v[82:83], v[28:29]
    v_lshlrev_b32 v26, 16, v78
    v_and_b32 v27, s58, v78
    v_pk_add_f32 v[84:85], v[84:85], v[26:27]
    v_lshlrev_b32 v28, 16, v79
    v_and_b32 v29, s58, v79
    v_pk_add_f32 v[86:87], v[86:87], v[28:29]
    v_cvt_pk_bf16_f32 v88, v80, v81
    v_cvt_pk_bf16_f32 v89, v82, v83
    v_cvt_pk_bf16_f32 v90, v84, v85
    v_cvt_pk_bf16_f32 v91, v86, v87
    buffer_store_dwordx2 v[88:89], v24, s[44:47], s57 offen
    v_cmp_gt_u32 vcc, 4, v22
    s_and_b64 exec, exec, vcc
    s_cbranch_execz L_end
    buffer_store_dwordx2 v[90:91], v24, s[44:47], s57 offen offset:32
L_end:
    s_endpgm
L_codeend:
    s_endpgm
.section .rodata,"a"
.p2align 6
.amdhsa_kernel standalone__gqa_block_cached__near_ridge_kernel
  .amdhsa_next_free_vgpr 256
  .amdhsa_next_free_sgpr 102
  .amdhsa_accum_offset 152
  .amdhsa_group_segment_fixed_size 0
  .amdhsa_kernarg_size 64
  .amdhsa_user_sgpr_count 2
  .amdhsa_user_sgpr_kernarg_segment_ptr 1
  .amdhsa_system_sgpr_workgroup_id_x 1
.end_amdhsa_kernel
```
